```python
import torch

def _softmax(x, axis=-1):
    return torch.softmax(x, dim=axis)
def _gelu(x):
    return torch.nn.functional.gelu(x, approximate="tanh")
def _silu(x):
    return torch.nn.functional.silu(x)
def _sigmoid(x):
    return torch.sigmoid(x)
def _layernorm(x, axis=-1, eps=1e-5):
    m = x.mean(dim=axis, keepdim=True)
    v = x.var(dim=axis, keepdim=True, unbiased=False)
    return (x - m) / torch.sqrt(v + eps)
def _scatter_add(tgt, idx, src, axis=0):
    return tgt.clone().index_add_(axis, idx, src)
def _segment_sum(src, seg, n):
    out = torch.zeros((n,) + src.shape[1:], dtype=src.dtype)
    return out.index_add_(0, seg, src)
def _pad(x, pw):
    flat = tuple(v for pair in reversed(pw) for v in pair)
    return torch.nn.functional.pad(x, flat)

kernel_name = 'sequential_preLN__sliding_block_cached__mixer_token_mlp__decode'

def setup_inputs():

    _w = (lambda a: (lambda t: t.to(torch.bfloat16) if t.is_floating_point() else t)(torch.as_tensor(a)))
    def _A_setup():
        B, Sq, D = 8, 1, 448
        Hq, Hkv, Sk, Dh = 16, 8, 4096, 256
        assert Hq % Hkv == 0, (Hq, Hkv)
        return {
            "x": _w((lambda *s: torch.randn(*s, dtype=torch.bfloat16) * 0.05)(B, Sq, D)),
            "k_cache": _w((lambda *s: torch.randn(*s, dtype=torch.bfloat16) * 0.8)(B, Hkv, Sk, Dh)),
            "v_cache": _w((lambda *s: torch.randn(*s, dtype=torch.bfloat16) * 0.8)(B, Hkv, Sk, Dh)),
            "wq": _w((lambda *s: torch.randn(*s, dtype=torch.bfloat16) * 0.8)(D, Hq * Dh) * (D ** -0.5)),
            "wo": _w((lambda *s: torch.randn(*s, dtype=torch.bfloat16) * 0.8)(Hq * Dh, D) * ((Hq * Dh) ** -0.5)),
        }
    _A_in = _A_setup()

    def _B_setup():
        B, S, D, F = 8, 1, 448, 1792
        return {
            "x": _w((lambda *s: torch.randn(*s, dtype=torch.bfloat16) * 0.05)(B, S, D)),
            "w1": _w((lambda *s: torch.randn(*s, dtype=torch.bfloat16) * 0.2)(S, F) * (S ** -0.5)),
            "b1": _w((lambda *s: torch.randn(*s, dtype=torch.bfloat16) * 0.2)(F) * 0.02),
            "w2": _w((lambda *s: torch.randn(*s, dtype=torch.bfloat16) * 0.2)(F, S) * (F ** -0.5)),
            "b2": _w((lambda *s: torch.randn(*s, dtype=torch.bfloat16) * 0.2)(S) * 0.02),
        }
    _B_in = _B_setup()

    return {
        "A_x": _A_in["x"],
        "A_k_cache": _A_in["k_cache"],
        "A_v_cache": _A_in["v_cache"],
        "A_wq": _A_in["wq"],
        "A_wo": _A_in["wo"],
        "B_x": _B_in["x"],
        "B_w1": _B_in["w1"],
        "B_b1": _B_in["b1"],
        "B_w2": _B_in["w2"],
        "B_b2": _B_in["b2"],
    }

def reference(A_x, A_k_cache, A_v_cache, A_wq, A_wo, B_x, B_w1, B_b1, B_w2, B_b2):
    def _A_ref(x, k_cache, v_cache, wq, wo):
        B, Sq, D = x.shape
        Hq, Dh = 16, 256
        Hkv, Sk = k_cache.shape[1], k_cache.shape[2]
        W = min(4096, max(256, Sk // 4))
        rep = Hq // Hkv
        q = (lambda x, *d: x.permute(*d))((x @ wq).reshape(B, Sq, Hq, Dh), 0, 2, 1, 3)
        k = (lambda x, n, axis: torch.repeat_interleave(x, n, dim=axis))(k_cache[:, :, Sk - W:, :], rep, axis=1)
        v = (lambda x, n, axis: torch.repeat_interleave(x, n, dim=axis))(v_cache[:, :, Sk - W:, :], rep, axis=1)
        scores = torch.einsum("bhqd,bhkd->bhqk", q, k) * (Dh ** -0.5)
        p = _softmax(scores, axis=-1)
        o = torch.einsum("bhqk,bhkd->bhqd", p, v)
        return (lambda x, *d: x.permute(*d))(o, 0, 2, 1, 3).reshape(B, Sq, Hq * Dh) @ wo

    def _B_ref(x, w1, b1, w2, b2):
        B, S, D = x.shape
        h = _layernorm(x, axis=-1)
        u = torch.einsum("bsd,sf->bdf", h, w1) + b1
        u = _gelu(u)
        y = torch.einsum("bdf,fs->bds", u, w2) + b2
        return (lambda x, *d: x.permute(*d))(y, 0, 2, 1)

    x = A_x
    h = x + _A_ref(_layernorm(x, axis=-1), A_k_cache, A_v_cache, A_wq, A_wo)
    h2 = h + _B_ref(_layernorm(h, axis=-1), B_w1, B_b1, B_w2, B_b2)
    return h2
```

```asm
; @launch grid=(256,1,1) block=(512,1,1) lds=161344
.amdgcn_target "amdgcn-amd-amdhsa--gfx950"
.text
.p2align 12
.globl sequential_preLN__sliding_block_cached__mixer_token_mlp__decode_kernel
.p2align 8
.type sequential_preLN__sliding_block_cached__mixer_token_mlp__decode_kernel,@function
sequential_preLN__sliding_block_cached__mixer_token_mlp__decode_kernel:
    s_load_dwordx16 s[4:19], s[0:1], 0
    s_load_dwordx8 s[20:27], s[0:1], 64
    s_load_dwordx2 s[28:29], s[0:1], 96
    v_lshrrev_b32 v1, 6, v0
    s_lshr_b32 s32, s2, 3
    v_readfirstlane_b32 s30, v1
    s_cmp_ge_u32 s32, 32
    s_cbranch_scc1 L_end
    v_and_b32 v0, 63, v0
    s_and_b32 s31, s2, 7
    v_lshlrev_b32 v3, 4, v0
    s_cmp_lt_u32 s30, 4
    s_cbranch_scc1 L_T
    s_lshr_b32 s34, s2, 5
    s_lshl3_add_u32 s34, s34, s31
    s_lshl2_add_u32 s34, s34, 3
    s_lshl_b32 s40, s34, 19
    s_bitcmp1_b32 s2, 3
    s_cselect_b32 s38, 24576, 0
    s_bitcmp1_b32 s2, 4
    s_cselect_b32 s35, 133120, 0
    s_xor_b32 s38, s38, s35
    s_bitcmp1_b32 s30, 0
    s_cselect_b32 s35, 331776, 0
    s_xor_b32 s38, s38, s35
    s_bitcmp1_b32 s30, 1
    s_cselect_b32 s35, 1024, 0
    s_xor_b32 s38, s38, s35
    s_sub_u32 s33, s30, 4
    s_lshl_b32 s37, s33, 15
    v_and_b32 v24, 32, v0
    v_lshlrev_b32 v24, 1, v24
    v_xor_b32 v24, v24, v3
    v_xor_b32 v12, s38, v24
    s_brev_b32 s54, 16
    s_mov_b32 s55, 0x20000
    s_mov_b32 m0, s37
    s_waitcnt lgkmcnt(0)
    s_mov_b64 s[52:53], s[6:7]
    buffer_load_dwordx4 v12, s[52:55], s40 offen nt lds
    s_add_u32 m0, s37, 1024
    v_xor_b32 v15, 12416, v12
    buffer_load_dwordx4 v15, s[52:55], s40 offen nt lds
    s_barrier
    s_add_u32 m0, s37, 2048
    v_xor_b32 v14, 262160, v12
    buffer_load_dwordx4 v14, s[52:55], s40 offen nt lds
    s_add_u32 m0, s37, 3072
    v_xor_b32 v15, 274576, v12
    buffer_load_dwordx4 v15, s[52:55], s40 offen nt lds
    s_add_u32 m0, s37, 4096
    v_xor_b32 v14, 32800, v12
    buffer_load_dwordx4 v14, s[52:55], s40 offen nt lds
    s_add_u32 m0, s37, 5120
    v_xor_b32 v15, 45216, v12
    buffer_load_dwordx4 v15, s[52:55], s40 offen nt lds
    s_add_u32 m0, s37, 6144
    v_xor_b32 v14, 294960, v12
    buffer_load_dwordx4 v14, s[52:55], s40 offen nt lds
    s_add_u32 m0, s37, 7168
    v_xor_b32 v15, 307376, v12
    buffer_load_dwordx4 v15, s[52:55], s40 offen nt lds
    s_branch L_S2
L_T:
    v_and_b32 v1, 15, v0
    v_lshrrev_b32 v2, 4, v0
    s_lshl_b32 s63, s31, 2
    v_mov_b32 v240, 0
    s_mov_b64 s[40:41], 0
    s_mov_b32 s46, 0
    s_cmp_eq_u32 s30, 0
    s_cbranch_scc1 L_T0
    s_cmp_eq_u32 s30, 3
    s_cbranch_scc1 L_T3
    s_cmp_eq_u32 s30, 1
    s_cbranch_scc1 L_T1
    s_getpc_b64 s[34:35]
L_pc:
    s_sub_u32 s34, s34, L_pc-sequential_preLN__sliding_block_cached__mixer_token_mlp__decode_kernel
    s_subb_u32 s35, s35, 0
    s_lshl_b32 s33, s32, 9
    v_min_u32 v180, 7, v0
    v_lshlrev_b32 v180, 6, v180
    v_add_u32 v180, s33, v180
    global_load_dword v182, v180, s[34:35]
    s_branch L_prepw
L_T1:
    s_mul_i32 s33, s32, 14*8192
    s_lshl_b32 s34, s31, 10
    s_add_u32 s33, s33, s34
    s_addk_i32 s33, 384
    v_min_u32 v180, 13, v1
    v_lshlrev_b32 v180, 13, v180
    v_and_b32 v181, 1, v2
    v_lshl_add_u32 v180, v181, 6, v180
    v_lshrrev_b32 v181, 1, v2
    v_lshl_add_u32 v180, v181, 9, v180
    v_add_u32 v180, s33, v180
    s_cmp_eq_u32 s31, 7
    s_cselect_b32 exec_hi, -1, 0
    s_and_b32 exec_hi, exec_hi, 0xffff
    s_mov_b32 exec_lo, 0xffff
    s_waitcnt lgkmcnt(0)
    global_load_dword v182, v180, s[10:11]
    s_mov_b64 exec, -1
    s_branch L_prepw
L_T3:
    s_sub_u32 s36, s32, 0
    s_cmp_lt_u32 s36, 4
    s_cbranch_scc0 L_prepw
    v_mov_b32 v184, -1
    v_mov_b32 v185, -1
    v_mov_b32 v186, -1
    v_mov_b32 v187, -1
    s_getreg_b32 s34, hwreg(HW_REG_XCC_ID, 0, 4)
    s_lshl_b32 s33, s36, 2
    s_lshl_b32 s34, s34, s33
    s_bitset1_b32 s34, 16
    s_lshl2_add_u32 s33, s31, s36
    s_lshl_b32 s35, s33, 13
    v_add_u32 v180, s35, v3
    s_lshl_b32 s33, s33, 6
    s_add_u32 s33, s33, 786432
    v_add_u32 v182, s33, v3
    s_waitcnt lgkmcnt(0)
    global_store_dwordx4 v180, v[184:187], s[28:29] offset:0
    global_store_dwordx4 v180, v[184:187], s[28:29] offset:1024
    global_store_dwordx4 v180, v[184:187], s[28:29] offset:2048
    global_store_dwordx4 v180, v[184:187], s[28:29] offset:3072
    v_add_u32 v180, 4096, v180
    global_store_dwordx4 v180, v[184:187], s[28:29] offset:0
    global_store_dwordx4 v180, v[184:187], s[28:29] offset:1024
    global_store_dwordx4 v180, v[184:187], s[28:29] offset:2048
    global_store_dwordx4 v180, v[184:187], s[28:29] offset:3072
    s_mov_b64 exec, 15
    global_store_dwordx4 v182, v[184:187], s[28:29]
    s_mov_b64 exec, -1
    s_mov_b32 s46, s34
    s_branch L_prepw
L_T0:
    v_lshrrev_b32 v240, 3, v0
    v_lshlrev_b32 v240, 13, v240
    v_and_b32 v180, 0x70, v3
    v_or_b32 v240, v240, v180
    s_xor_b32 s34, s32, 16
    s_lshr_b32 s35, s34, 2
    s_lshl3_add_u32 s50, s31, s35
    s_lshl_b32 s50, s50, 7
    s_and_b32 s48, s34, 3
    s_mul_i32 s34, s48, 112*8192
    s_add_u32 s50, s50, s34
    s_movk_i32 s58, 7168
    s_mov_b32 s59, 0x20000
    s_lshl_b32 s33, s31, 15
    s_lshl_b32 s34, s32, 10
    s_add_u32 s33, s33, s34
    s_add_u32 s33, s33, 262144
    v_add_u32 v180, s33, v3
    s_lshl_b32 s33, s31, 15
    s_min_u32 s34, s32, 27
    s_lshl_b32 s34, s34, 9
    s_add_u32 s33, s33, s34
    s_add_u32 s33, s33, 524288
    s_cmp_ge_u32 s32, 14
    s_cselect_b32 s34, 9216, 0
    s_add_u32 s40, s33, s34
    s_getreg_b32 s34, hwreg(HW_REG_XCC_ID, 2, 1)
    s_lshl_b32 s34, s34, 13
    s_add_u32 s33, s40, s34
    v_add_u32 v181, s33, v3
    s_lshl_b32 s33, s31, 5
    s_add_u32 s33, s33, s32
    s_mul_i32 s33, s33, 48
    s_add_u32 s33, s33, 851456
    v_add_u32 v182, s33, v3
    v_cmp_gt_u32 vcc, 32, v0
    s_nop 1
    v_cndmask_b32 v181, v182, v181, vcc
    v_mov_b32 v60, -1
    v_mov_b32 v61, -1
    v_mov_b32 v62, -1
    v_mov_b32 v63, -1
    s_waitcnt lgkmcnt(0)
    s_mov_b64 s[56:57], s[4:5]
    s_mov_b32 m0, 146688
    s_movk_i32 s35, 4096
    buffer_load_dwordx4 v3, s[56:59], 0 offen offset:0  lds
    buffer_load_dwordx4 v3, s[56:59], 0 offen offset:1024  lds
    buffer_load_dwordx4 v3, s[56:59], 0 offen offset:2048  lds
    buffer_load_dwordx4 v3, s[56:59], 0 offen offset:3072  lds
    s_mov_b32 m0, 150784
    s_nop 0
    buffer_load_dwordx4 v3, s[56:59], s35 offen offset:0  lds
    buffer_load_dwordx4 v3, s[56:59], s35 offen offset:1024  lds
    buffer_load_dwordx4 v3, s[56:59], s35 offen offset:2048  lds
    global_store_dwordx4 v180, v[60:63], s[28:29]
    s_cmp_lt_u32 s32, 28
    s_cselect_b32 exec_lo, -1, 0
    s_mov_b32 exec_hi, 7
    global_store_dwordx4 v181, v[60:63], s[28:29] sc1
    s_mov_b64 exec, -1
    s_branch L_prepw
L_S2:
    v_and_b32 v1, 15, v0
    v_lshrrev_b32 v2, 4, v0
    s_mov_b64 s[56:57], s[8:9]
    s_mov_b32 s58, s54
    s_mov_b32 s59, 0x20000
    s_mov_b32 s61, 0
    v_and_b32 v24, 1, v2
    v_lshlrev_b32 v24, 9, v24
    v_lshl_add_u32 v24, v1, 4, v24
    v_lshrrev_b32 v25, 1, v2
    v_mul_u32_u24 v25, 12288, v25
    v_or_b32 v24, v24, v25
    s_or_b32 s35, s38, s61
    v_xor_b32 v13, s35, v24
    v_mov_b32 v27, v1
    v_and_b32 v24, 3, v1
    v_lshrrev_b32 v25, 2, v1
    v_lshl_add_u32 v26, v24, 2, v25
    v_xor_b32 v27, v27, v2
    v_lshlrev_b32 v26, 9, v26
    v_add_u32 v26, s37, v26
    v_lshl_add_u32 v16, v27, 4, v26
    v_xor_b32 v17, 64, v16
    v_xor_b32 v18, 128, v16
    v_xor_b32 v19, 192, v16
    v_lshrrev_b32 v24, 3, v1
    v_lshlrev_b32 v34, 9, v24
    v_lshl_add_u32 v34, v2, 4, v34
    v_add_u32 v34, 145408, v34
    v_lshlrev_b32 v36, 5, v24
    v_add_u32 v36, 146432, v36
    s_lshl_b32 s35, s33, 2
    v_add_u32 v35, s35, v36
    v_and_b32 v24, 16, v3
    v_mov_b32 v25, 0xffff
    v_lshlrev_b32 v25, v24, v25
    v_bfe_u32 v24, v1, 1, 2
    v_cmp_eq_u32 vcc, 0, v24
    s_nop 1
    v_cndmask_b32 v20, 0, v25, vcc
    v_cmp_eq_u32 vcc, 1, v24
    s_nop 1
    v_cndmask_b32 v21, 0, v25, vcc
    v_cmp_eq_u32 vcc, 2, v24
    s_nop 1
    v_cndmask_b32 v22, 0, v25, vcc
    v_cmp_eq_u32 vcc, 3, v24
    s_nop 1
    v_cndmask_b32 v23, 0, v25, vcc
    v_and_b32 v24, 1, v2
    v_lshlrev_b32 v24, 4, v24
    v_lshrrev_b32 v25, 1, v2
    v_lshl_add_u32 v24, v25, 10, v24
    v_lshl_add_u32 v24, v1, 5, v24
    s_lshl_b32 s35, s33, 11
    s_add_u32 s35, s35, 146688
    s_xor_b32 s38, s61, 0
    s_lshl1_add_u32 s38, s38, s35
    v_add_u32 v32, s38, v24
    s_xor_b32 s38, s61, 256
    s_lshl1_add_u32 s38, s38, s35
    v_add_u32 v33, s38, v24
    v_xor_b32 v56, 2048, v12
    v_xor_b32 v57, 14464, v12
    v_xor_b32 v58, 264208, v12
    v_xor_b32 v59, 276624, v12
    v_xor_b32 v60, 34848, v12
    v_xor_b32 v61, 47264, v12
    v_xor_b32 v62, 297008, v12
    v_xor_b32 v63, 309424, v12
    v_xor_b32 v64, 4096, v12
    v_xor_b32 v65, 8320, v12
    v_xor_b32 v66, 266256, v12
    v_xor_b32 v67, 270480, v12
    v_xor_b32 v68, 36896, v12
    v_xor_b32 v69, 41120, v12
    v_xor_b32 v70, 299056, v12
    v_xor_b32 v71, 303280, v12
    v_xor_b32 v72, 6144, v12
    v_xor_b32 v73, 10368, v12
    v_xor_b32 v74, 268304, v12
    v_xor_b32 v75, 272528, v12
    v_xor_b32 v76, 38944, v12
    v_xor_b32 v77, 43168, v12
    v_xor_b32 v78, 301104, v12
    v_xor_b32 v79, 305328, v12
    v_xor_b32 v81, 256, v13
    v_xor_b32 v82, 32768, v13
    v_xor_b32 v83, 33024, v13
    v_xor_b32 v84, 262144, v13
    v_xor_b32 v85, 262400, v13
    v_xor_b32 v86, 294912, v13
    v_xor_b32 v87, 295168, v13
    v_xor_b32 v88, 4096, v13
    v_xor_b32 v89, 4352, v13
    v_xor_b32 v90, 36864, v13
    v_xor_b32 v91, 37120, v13
    v_xor_b32 v92, 266240, v13
    v_xor_b32 v93, 266496, v13
    s_add_u32 m0, s37, 8192
    s_nop 0
    buffer_load_dwordx4 v56, s[52:55], s40 offen nt lds
    s_barrier
    s_add_u32 m0, s37, 9216
    s_waitcnt vmcnt(8)
    buffer_load_dwordx4 v57, s[52:55], s40 offen nt lds
    s_add_u32 m0, s37, 10240
    s_waitcnt vmcnt(8)
    buffer_load_dwordx4 v58, s[52:55], s40 offen nt lds
    s_add_u32 m0, s37, 11264
    s_waitcnt vmcnt(8)
    buffer_load_dwordx4 v59, s[52:55], s40 offen nt lds
    s_add_u32 m0, s37, 12288
    s_waitcnt vmcnt(8)
    buffer_load_dwordx4 v60, s[52:55], s40 offen nt lds
    s_add_u32 m0, s37, 13312
    s_waitcnt vmcnt(8)
    buffer_load_dwordx4 v61, s[52:55], s40 offen nt lds
    s_add_u32 m0, s37, 14336
    s_waitcnt vmcnt(8)
    buffer_load_dwordx4 v62, s[52:55], s40 offen nt lds
    s_add_u32 m0, s37, 15360
    s_waitcnt vmcnt(8)
    buffer_load_dwordx4 v63, s[52:55], s40 offen nt lds
    s_add_u32 m0, s37, 16384
    s_waitcnt vmcnt(8)
    buffer_load_dwordx4 v64, s[52:55], s40 offen nt lds
    s_add_u32 m0, s37, 17408
    s_waitcnt vmcnt(8)
    buffer_load_dwordx4 v65, s[52:55], s40 offen nt lds
    s_add_u32 m0, s37, 18432
    s_waitcnt vmcnt(8)
    buffer_load_dwordx4 v66, s[52:55], s40 offen nt lds
    s_add_u32 m0, s37, 19456
    s_waitcnt vmcnt(8)
    buffer_load_dwordx4 v67, s[52:55], s40 offen nt lds
    s_add_u32 m0, s37, 20480
    s_waitcnt vmcnt(8)
    buffer_load_dwordx4 v68, s[52:55], s40 offen nt lds
    s_add_u32 m0, s37, 21504
    s_waitcnt vmcnt(8)
    buffer_load_dwordx4 v69, s[52:55], s40 offen nt lds
    s_add_u32 m0, s37, 22528
    s_waitcnt vmcnt(8)
    buffer_load_dwordx4 v70, s[52:55], s40 offen nt lds
    s_add_u32 m0, s37, 23552
    s_waitcnt vmcnt(8)
    buffer_load_dwordx4 v71, s[52:55], s40 offen nt lds
    s_add_u32 m0, s37, 24576
    s_waitcnt vmcnt(8)
    buffer_load_dwordx4 v72, s[52:55], s40 offen nt lds
    s_add_u32 m0, s37, 25600
    s_waitcnt vmcnt(8)
    buffer_load_dwordx4 v73, s[52:55], s40 offen nt lds
    s_add_u32 m0, s37, 26624
    s_waitcnt vmcnt(8)
    buffer_load_dwordx4 v74, s[52:55], s40 offen nt lds
    s_add_u32 m0, s37, 27648
    s_waitcnt vmcnt(8)
    buffer_load_dwordx4 v75, s[52:55], s40 offen nt lds
    s_add_u32 m0, s37, 28672
    s_waitcnt vmcnt(8)
    buffer_load_dwordx4 v76, s[52:55], s40 offen nt lds
    s_add_u32 m0, s37, 29696
    s_waitcnt vmcnt(8)
    buffer_load_dwordx4 v77, s[52:55], s40 offen nt lds
    s_add_u32 m0, s37, 30720
    s_waitcnt vmcnt(8)
    buffer_load_dwordx4 v78, s[52:55], s40 offen nt lds
    s_add_u32 m0, s37, 31744
    s_waitcnt vmcnt(8)
    buffer_load_dwordx4 v79, s[52:55], s40 offen nt lds
    s_waitcnt vmcnt(8)
    buffer_load_dwordx4 v[120:123], v13, s[56:59], s40 offen nt
    s_waitcnt vmcnt(8)
    buffer_load_dwordx4 v[124:127], v81, s[56:59], s40 offen nt
    s_barrier
    s_waitcnt vmcnt(8)
    buffer_load_dwordx4 v[136:139], v82, s[56:59], s40 offen nt
    s_waitcnt vmcnt(8)
    buffer_load_dwordx4 v[140:143], v83, s[56:59], s40 offen nt
    s_waitcnt vmcnt(8)
    buffer_load_dwordx4 v[128:131], v84, s[56:59], s40 offen nt
    s_waitcnt vmcnt(8)
    buffer_load_dwordx4 v[132:135], v85, s[56:59], s40 offen nt
    s_waitcnt vmcnt(8)
    buffer_load_dwordx4 v[144:147], v86, s[56:59], s40 offen nt
    s_waitcnt vmcnt(8)
    buffer_load_dwordx4 v[148:151], v87, s[56:59], s40 offen nt
    s_waitcnt vmcnt(8)
    buffer_load_dwordx4 v[184:187], v88, s[56:59], s40 offen nt
    s_waitcnt vmcnt(8)
    buffer_load_dwordx4 v[188:191], v89, s[56:59], s40 offen nt
    s_waitcnt vmcnt(8)
    buffer_load_dwordx4 v[200:203], v90, s[56:59], s40 offen nt
    s_waitcnt vmcnt(8)
    buffer_load_dwordx4 v[204:207], v91, s[56:59], s40 offen nt
    s_waitcnt vmcnt(8)
    buffer_load_dwordx4 v[192:195], v92, s[56:59], s40 offen nt
    s_waitcnt vmcnt(8)
    buffer_load_dwordx4 v[196:199], v93, s[56:59], s40 offen nt
    s_barrier
    ds_read_b128 v[56:59], v34 offset:0
    ds_read_b128 v[60:63], v34 offset:64
    ds_read_b128 v[64:67], v34 offset:128
    ds_read_b128 v[68:71], v34 offset:192
    ds_read_b128 v[72:75], v34 offset:256
    ds_read_b128 v[76:79], v34 offset:320
    ds_read_b128 v[80:83], v34 offset:384
    ds_read_b128 v[84:87], v34 offset:448
    ds_read_b128 v[88:91], v16 offset:0
    ds_read_b128 v[92:95], v17 offset:0
    ds_read_b128 v[96:99], v18 offset:0
    ds_read_b128 v[100:103], v19 offset:0
    ds_read_b128 v[104:107], v16 offset:256
    ds_read_b128 v[108:111], v17 offset:256
    ds_read_b128 v[112:115], v18 offset:256
    ds_read_b128 v[116:119], v19 offset:256
    s_waitcnt lgkmcnt(7)
    v_mfma_f32_16x16x32_bf16 v[40:43], v[88:91], v[56:59], 0
    s_waitcnt lgkmcnt(6)
    v_mfma_f32_16x16x32_bf16 v[40:43], v[92:95], v[60:63], v[40:43]
    s_waitcnt lgkmcnt(5)
    v_mfma_f32_16x16x32_bf16 v[40:43], v[96:99], v[64:67], v[40:43]
    s_waitcnt lgkmcnt(4)
    v_mfma_f32_16x16x32_bf16 v[40:43], v[100:103], v[68:71], v[40:43]
    s_waitcnt lgkmcnt(3)
    v_mfma_f32_16x16x32_bf16 v[40:43], v[104:107], v[72:75], v[40:43]
    s_waitcnt lgkmcnt(2)
    v_mfma_f32_16x16x32_bf16 v[40:43], v[108:111], v[76:79], v[40:43]
    s_waitcnt lgkmcnt(1)
    v_mfma_f32_16x16x32_bf16 v[40:43], v[112:115], v[80:83], v[40:43]
    s_waitcnt lgkmcnt(0)
    v_mfma_f32_16x16x32_bf16 v[40:43], v[116:119], v[84:87], v[40:43]
    v_xor_b32 v14, 299008, v13
    s_waitcnt vmcnt(8)
    buffer_load_dwordx4 v[208:211], v14, s[56:59], s40 offen nt
    ds_read_b128 v[88:91], v16 offset:8192
    ds_read_b128 v[92:95], v17 offset:8192
    ds_read_b128 v[96:99], v18 offset:8192
    ds_read_b128 v[100:103], v19 offset:8192
    ds_read_b128 v[104:107], v16 offset:8448
    ds_read_b128 v[108:111], v17 offset:8448
    ds_read_b128 v[112:115], v18 offset:8448
    ds_read_b128 v[116:119], v19 offset:8448
    s_waitcnt lgkmcnt(7)
    v_mfma_f32_16x16x32_bf16 v[44:47], v[88:91], v[56:59], 0
    s_waitcnt lgkmcnt(6)
    v_mfma_f32_16x16x32_bf16 v[44:47], v[92:95], v[60:63], v[44:47]
    s_waitcnt lgkmcnt(5)
    v_mfma_f32_16x16x32_bf16 v[44:47], v[96:99], v[64:67], v[44:47]
    s_waitcnt lgkmcnt(4)
    v_mfma_f32_16x16x32_bf16 v[44:47], v[100:103], v[68:71], v[44:47]
    s_waitcnt lgkmcnt(3)
    v_mfma_f32_16x16x32_bf16 v[44:47], v[104:107], v[72:75], v[44:47]
    s_waitcnt lgkmcnt(2)
    v_mfma_f32_16x16x32_bf16 v[44:47], v[108:111], v[76:79], v[44:47]
    s_waitcnt lgkmcnt(1)
    v_mfma_f32_16x16x32_bf16 v[44:47], v[112:115], v[80:83], v[44:47]
    s_waitcnt lgkmcnt(0)
    v_mfma_f32_16x16x32_bf16 v[44:47], v[116:119], v[84:87], v[44:47]
    v_xor_b32 v15, 299264, v13
    s_waitcnt vmcnt(8)
    buffer_load_dwordx4 v[212:215], v15, s[56:59], s40 offen nt
    ds_read_b128 v[88:91], v16 offset:16384
    ds_read_b128 v[92:95], v17 offset:16384
    ds_read_b128 v[96:99], v18 offset:16384
    ds_read_b128 v[100:103], v19 offset:16384
    ds_read_b128 v[104:107], v16 offset:16640
    ds_read_b128 v[108:111], v17 offset:16640
    ds_read_b128 v[112:115], v18 offset:16640
    ds_read_b128 v[116:119], v19 offset:16640
    s_waitcnt lgkmcnt(7)
    v_mfma_f32_16x16x32_bf16 v[48:51], v[88:91], v[56:59], 0
    s_waitcnt lgkmcnt(6)
    v_mfma_f32_16x16x32_bf16 v[48:51], v[92:95], v[60:63], v[48:51]
    s_waitcnt lgkmcnt(5)
    v_mfma_f32_16x16x32_bf16 v[48:51], v[96:99], v[64:67], v[48:51]
    s_waitcnt lgkmcnt(4)
    v_mfma_f32_16x16x32_bf16 v[48:51], v[100:103], v[68:71], v[48:51]
    s_waitcnt lgkmcnt(3)
    v_mfma_f32_16x16x32_bf16 v[48:51], v[104:107], v[72:75], v[48:51]
    s_waitcnt lgkmcnt(2)
    v_mfma_f32_16x16x32_bf16 v[48:51], v[108:111], v[76:79], v[48:51]
    s_waitcnt lgkmcnt(1)
    v_mfma_f32_16x16x32_bf16 v[48:51], v[112:115], v[80:83], v[48:51]
    s_waitcnt lgkmcnt(0)
    v_mfma_f32_16x16x32_bf16 v[48:51], v[116:119], v[84:87], v[48:51]
    v_xor_b32 v14, 2048, v13
    s_waitcnt vmcnt(8)
    buffer_load_dwordx4 v[152:155], v14, s[56:59], s40 offen nt
    ds_read_b128 v[88:91], v16 offset:24576
    ds_read_b128 v[92:95], v17 offset:24576
    ds_read_b128 v[96:99], v18 offset:24576
    ds_read_b128 v[100:103], v19 offset:24576
    ds_read_b128 v[104:107], v16 offset:24832
    ds_read_b128 v[108:111], v17 offset:24832
    ds_read_b128 v[112:115], v18 offset:24832
    ds_read_b128 v[116:119], v19 offset:24832
    s_waitcnt lgkmcnt(7)
    v_mfma_f32_16x16x32_bf16 v[52:55], v[88:91], v[56:59], 0
    s_waitcnt lgkmcnt(6)
    v_mfma_f32_16x16x32_bf16 v[52:55], v[92:95], v[60:63], v[52:55]
    s_waitcnt lgkmcnt(5)
    v_mfma_f32_16x16x32_bf16 v[52:55], v[96:99], v[64:67], v[52:55]
    s_waitcnt lgkmcnt(4)
    v_mfma_f32_16x16x32_bf16 v[52:55], v[100:103], v[68:71], v[52:55]
    s_waitcnt lgkmcnt(3)
    v_mfma_f32_16x16x32_bf16 v[52:55], v[104:107], v[72:75], v[52:55]
    s_waitcnt lgkmcnt(2)
    v_mfma_f32_16x16x32_bf16 v[52:55], v[108:111], v[76:79], v[52:55]
    s_waitcnt lgkmcnt(1)
    v_mfma_f32_16x16x32_bf16 v[52:55], v[112:115], v[80:83], v[52:55]
    s_waitcnt lgkmcnt(0)
    v_mfma_f32_16x16x32_bf16 v[52:55], v[116:119], v[84:87], v[52:55]
    v_xor_b32 v15, 2304, v13
    s_waitcnt vmcnt(8)
    buffer_load_dwordx4 v[156:159], v15, s[56:59], s40 offen nt
    s_mov_b32 s35, 0x3db8aa3b
    v_max3_f32 v24, v40, v41, v42
    v_max3_f32 v24, v24, v43, v44
    v_max3_f32 v24, v24, v45, v46
    v_max3_f32 v24, v24, v47, v48
    v_max3_f32 v24, v24, v49, v50
    v_max3_f32 v24, v24, v51, v52
    v_max3_f32 v24, v24, v53, v54
    v_max_f32 v24, v24, v55
    v_mov_b32 v25, v24
    s_nop 1
    v_permlane32_swap_b32 v24, v25
    v_max_f32 v24, v24, v25
    v_mov_b32 v25, v24
    s_nop 1
    v_permlane16_swap_b32 v24, v25
    v_max_f32 v24, v24, v25
    v_mul_f32 v24, s35, v24
    v_fma_f32 v40, v40, s35, -v24
    v_fma_f32 v41, v41, s35, -v24
    v_fma_f32 v42, v42, s35, -v24
    v_fma_f32 v43, v43, s35, -v24
    v_fma_f32 v44, v44, s35, -v24
    v_fma_f32 v45, v45, s35, -v24
    v_fma_f32 v46, v46, s35, -v24
    v_fma_f32 v47, v47, s35, -v24
    v_fma_f32 v48, v48, s35, -v24
    v_fma_f32 v49, v49, s35, -v24
    v_fma_f32 v50, v50, s35, -v24
    v_fma_f32 v51, v51, s35, -v24
    v_fma_f32 v52, v52, s35, -v24
    v_fma_f32 v53, v53, s35, -v24
    v_fma_f32 v54, v54, s35, -v24
    v_fma_f32 v55, v55, s35, -v24
    v_exp_f32 v40, v40
    v_exp_f32 v41, v41
    v_exp_f32 v42, v42
    v_exp_f32 v43, v43
    v_exp_f32 v44, v44
    v_exp_f32 v45, v45
    v_exp_f32 v46, v46
    v_exp_f32 v47, v47
    v_exp_f32 v48, v48
    v_exp_f32 v49, v49
    v_exp_f32 v50, v50
    v_exp_f32 v51, v51
    v_exp_f32 v52, v52
    v_exp_f32 v53, v53
    v_exp_f32 v54, v54
    v_exp_f32 v55, v55
    v_add_f32 v26, v40, v41
    v_add_f32 v26, v26, v42
    v_add_f32 v26, v26, v43
    v_add_f32 v26, v26, v44
    v_add_f32 v26, v26, v45
    v_add_f32 v26, v26, v46
    v_add_f32 v26, v26, v47
    v_add_f32 v26, v26, v48
    v_add_f32 v26, v26, v49
    v_add_f32 v26, v26, v50
    v_add_f32 v26, v26, v51
    v_add_f32 v26, v26, v52
    v_add_f32 v26, v26, v53
    v_add_f32 v26, v26, v54
    v_add_f32 v26, v26, v55
    v_mov_b32 v25, v26
    s_nop 1
    v_permlane32_swap_b32 v26, v25
    v_add_f32 v26, v26, v25
    v_mov_b32 v25, v26
    s_nop 1
    v_permlane16_swap_b32 v26, v25
    v_add_f32 v26, v26, v25
    ds_write2_b32 v35, v24, v26 offset0:0 offset1:4
    v_xor_b32 v14, 34816, v13
    s_waitcnt vmcnt(8)
    buffer_load_dwordx4 v[168:171], v14, s[56:59], s40 offen nt
    s_waitcnt lgkmcnt(0)
    s_barrier
    ds_read_b128 v[4:7], v36
    ds_read_b128 v[8:11], v36 offset:16
    v_xor_b32 v15, 35072, v13
    s_waitcnt vmcnt(8)
    buffer_load_dwordx4 v[172:175], v15, s[56:59], s40 offen nt
    s_waitcnt lgkmcnt(0)
    v_max3_f32 v27, v4, v5, v6
    v_max_f32 v27, v27, v7
    v_sub_f32 v4, v4, v27
    v_sub_f32 v5, v5, v27
    v_sub_f32 v6, v6, v27
    v_sub_f32 v7, v7, v27
    v_exp_f32 v4, v4
    v_exp_f32 v5, v5
    v_exp_f32 v6, v6
    v_exp_f32 v7, v7
    v_mul_f32 v28, v4, v8
    v_fmac_f32 v28, v5, v9
    v_fmac_f32 v28, v6, v10
    v_fmac_f32 v28, v7, v11
    v_sub_f32 v24, v24, v27
    v_exp_f32 v24, v24
    v_rcp_f32 v28, v28
    s_nop 0
    v_mul_f32 v24, v24, v28
    v_mul_f32 v40, v40, v24
    v_cvt_pk_bf16_f32 v40, v40, v40
    v_and_b32 v56, v40, v20
    v_and_b32 v57, v40, v21
    v_and_b32 v58, v40, v22
    v_and_b32 v59, v40, v23
    v_mul_f32 v41, v41, v24
    v_cvt_pk_bf16_f32 v41, v41, v41
    v_and_b32 v60, v41, v20
    v_and_b32 v61, v41, v21
    v_and_b32 v62, v41, v22
    v_and_b32 v63, v41, v23
    v_mul_f32 v42, v42, v24
    v_cvt_pk_bf16_f32 v42, v42, v42
    v_and_b32 v64, v42, v20
    v_and_b32 v65, v42, v21
    v_and_b32 v66, v42, v22
    v_and_b32 v67, v42, v23
    v_mul_f32 v43, v43, v24
    v_cvt_pk_bf16_f32 v43, v43, v43
    v_and_b32 v68, v43, v20
    v_and_b32 v69, v43, v21
    v_and_b32 v70, v43, v22
    v_and_b32 v71, v43, v23
    v_mul_f32 v44, v44, v24
    v_cvt_pk_bf16_f32 v44, v44, v44
    v_and_b32 v72, v44, v20
    v_and_b32 v73, v44, v21
    v_and_b32 v74, v44, v22
    v_and_b32 v75, v44, v23
    v_mul_f32 v45, v45, v24
    v_cvt_pk_bf16_f32 v45, v45, v45
    v_and_b32 v76, v45, v20
    v_and_b32 v77, v45, v21
    v_and_b32 v78, v45, v22
    v_and_b32 v79, v45, v23
    v_mul_f32 v46, v46, v24
    v_cvt_pk_bf16_f32 v46, v46, v46
    v_and_b32 v80, v46, v20
    v_and_b32 v81, v46, v21
    v_and_b32 v82, v46, v22
    v_and_b32 v83, v46, v23
    v_mul_f32 v47, v47, v24
    v_cvt_pk_bf16_f32 v47, v47, v47
    v_and_b32 v84, v47, v20
    v_and_b32 v85, v47, v21
    v_and_b32 v86, v47, v22
    v_and_b32 v87, v47, v23
    v_xor_b32 v14, 264192, v13
    s_waitcnt vmcnt(8)
    buffer_load_dwordx4 v[160:163], v14, s[56:59], s40 offen nt
    v_mul_f32 v48, v48, v24
    v_cvt_pk_bf16_f32 v48, v48, v48
    v_and_b32 v88, v48, v20
    v_and_b32 v89, v48, v21
    v_and_b32 v90, v48, v22
    v_and_b32 v91, v48, v23
    v_mul_f32 v49, v49, v24
    v_cvt_pk_bf16_f32 v49, v49, v49
    v_and_b32 v92, v49, v20
    v_and_b32 v93, v49, v21
    v_and_b32 v94, v49, v22
    v_and_b32 v95, v49, v23
    v_mul_f32 v50, v50, v24
    v_cvt_pk_bf16_f32 v50, v50, v50
    v_and_b32 v96, v50, v20
    v_and_b32 v97, v50, v21
    v_and_b32 v98, v50, v22
    v_and_b32 v99, v50, v23
    v_mul_f32 v51, v51, v24
    v_cvt_pk_bf16_f32 v51, v51, v51
    v_and_b32 v100, v51, v20
    v_and_b32 v101, v51, v21
    v_and_b32 v102, v51, v22
    v_and_b32 v103, v51, v23
    v_mul_f32 v52, v52, v24
    v_cvt_pk_bf16_f32 v52, v52, v52
    v_and_b32 v104, v52, v20
    v_and_b32 v105, v52, v21
    v_and_b32 v106, v52, v22
    v_and_b32 v107, v52, v23
    v_mul_f32 v53, v53, v24
    v_cvt_pk_bf16_f32 v53, v53, v53
    v_and_b32 v108, v53, v20
    v_and_b32 v109, v53, v21
    v_and_b32 v110, v53, v22
    v_and_b32 v111, v53, v23
    v_mul_f32 v54, v54, v24
    v_cvt_pk_bf16_f32 v54, v54, v54
    v_and_b32 v112, v54, v20
    v_and_b32 v113, v54, v21
    v_and_b32 v114, v54, v22
    v_and_b32 v115, v54, v23
    v_mul_f32 v55, v55, v24
    v_cvt_pk_bf16_f32 v55, v55, v55
    v_and_b32 v116, v55, v20
    v_and_b32 v117, v55, v21
    v_and_b32 v118, v55, v22
    v_and_b32 v119, v55, v23
    v_xor_b32 v15, 264448, v13
    s_waitcnt vmcnt(8)
    buffer_load_dwordx4 v[164:167], v15, s[56:59], s40 offen nt
    v_xor_b32 v14, 296960, v13
    s_waitcnt vmcnt(8)
    buffer_load_dwordx4 v[176:179], v14, s[56:59], s40 offen nt
    v_mfma_f32_16x16x32_bf16 v[4:7], v[56:59], v[120:123], 0
    v_mfma_f32_16x16x32_bf16 v[8:11], v[56:59], v[124:127], 0
    v_mfma_f32_16x16x32_bf16 v[4:7], v[64:67], v[136:139], v[4:7]
    v_mfma_f32_16x16x32_bf16 v[8:11], v[64:67], v[140:143], v[8:11]
    v_xor_b32 v15, 297216, v13
    s_waitcnt vmcnt(8)
    buffer_load_dwordx4 v[180:183], v15, s[56:59], s40 offen nt
    v_mfma_f32_16x16x32_bf16 v[4:7], v[60:63], v[128:131], v[4:7]
    v_mfma_f32_16x16x32_bf16 v[8:11], v[60:63], v[132:135], v[8:11]
    v_mfma_f32_16x16x32_bf16 v[4:7], v[68:71], v[144:147], v[4:7]
    v_mfma_f32_16x16x32_bf16 v[8:11], v[68:71], v[148:151], v[8:11]
    v_xor_b32 v14, 6144, v13
    s_waitcnt vmcnt(8)
    buffer_load_dwordx4 v[216:219], v14, s[56:59], s40 offen nt
    v_mfma_f32_16x16x32_bf16 v[4:7], v[88:91], v[184:187], v[4:7]
    v_mfma_f32_16x16x32_bf16 v[8:11], v[88:91], v[188:191], v[8:11]
    v_mfma_f32_16x16x32_bf16 v[4:7], v[96:99], v[200:203], v[4:7]
    v_mfma_f32_16x16x32_bf16 v[8:11], v[96:99], v[204:207], v[8:11]
    v_xor_b32 v15, 6400, v13
    s_waitcnt vmcnt(8)
    buffer_load_dwordx4 v[220:223], v15, s[56:59], s40 offen nt
    v_mfma_f32_16x16x32_bf16 v[4:7], v[92:95], v[192:195], v[4:7]
    v_mfma_f32_16x16x32_bf16 v[8:11], v[92:95], v[196:199], v[8:11]
    v_mfma_f32_16x16x32_bf16 v[4:7], v[100:103], v[208:211], v[4:7]
    v_mfma_f32_16x16x32_bf16 v[8:11], v[100:103], v[212:215], v[8:11]
    v_xor_b32 v14, 38912, v13
    s_waitcnt vmcnt(8)
    buffer_load_dwordx4 v[232:235], v14, s[56:59], s40 offen nt
    v_mfma_f32_16x16x32_bf16 v[4:7], v[72:75], v[152:155], v[4:7]
    v_mfma_f32_16x16x32_bf16 v[8:11], v[72:75], v[156:159], v[8:11]
    v_xor_b32 v15, 39168, v13
    s_waitcnt vmcnt(8)
    buffer_load_dwordx4 v[236:239], v15, s[56:59], s40 offen nt
    v_mfma_f32_16x16x32_bf16 v[4:7], v[80:83], v[168:171], v[4:7]
    v_xor_b32 v14, 268288, v13
    s_waitcnt vmcnt(8)
    buffer_load_dwordx4 v[224:227], v14, s[56:59], s40 offen nt
    v_mfma_f32_16x16x32_bf16 v[8:11], v[80:83], v[172:175], v[8:11]
    v_xor_b32 v15, 301056, v13
    s_waitcnt vmcnt(8)
    buffer_load_dwordx4 v[240:243], v15, s[56:59], s40 offen nt
    v_mfma_f32_16x16x32_bf16 v[4:7], v[76:79], v[160:163], v[4:7]
    v_xor_b32 v14, 268544, v13
    s_waitcnt vmcnt(8)
    buffer_load_dwordx4 v[228:231], v14, s[56:59], s40 offen nt
    v_mfma_f32_16x16x32_bf16 v[8:11], v[76:79], v[164:167], v[8:11]
    v_xor_b32 v15, 301312, v13
    s_waitcnt vmcnt(8)
    buffer_load_dwordx4 v[244:247], v15, s[56:59], s40 offen nt
    s_barrier
    v_mfma_f32_16x16x32_bf16 v[4:7], v[84:87], v[176:179], v[4:7]
    s_waitcnt vmcnt(8)
    v_mfma_f32_16x16x32_bf16 v[8:11], v[84:87], v[180:183], v[8:11]
    s_waitcnt vmcnt(7)
    v_mfma_f32_16x16x32_bf16 v[4:7], v[104:107], v[216:219], v[4:7]
    s_waitcnt vmcnt(6)
    v_mfma_f32_16x16x32_bf16 v[8:11], v[104:107], v[220:223], v[8:11]
    s_waitcnt vmcnt(5)
    v_mfma_f32_16x16x32_bf16 v[4:7], v[112:115], v[232:235], v[4:7]
    s_waitcnt vmcnt(4)
    v_mfma_f32_16x16x32_bf16 v[8:11], v[112:115], v[236:239], v[8:11]
    s_waitcnt vmcnt(3)
    v_mfma_f32_16x16x32_bf16 v[4:7], v[108:111], v[224:227], v[4:7]
    s_waitcnt vmcnt(2)
    v_mfma_f32_16x16x32_bf16 v[4:7], v[116:119], v[240:243], v[4:7]
    s_waitcnt vmcnt(1)
    v_mfma_f32_16x16x32_bf16 v[8:11], v[108:111], v[228:231], v[8:11]
    s_nop 5
    ds_write_b128 v32, v[4:7]
    s_waitcnt vmcnt(0)
    v_mfma_f32_16x16x32_bf16 v[8:11], v[116:119], v[244:247], v[8:11]
    s_nop 7
    ds_write_b128 v33, v[8:11]
    s_waitcnt lgkmcnt(0)
    s_barrier
    s_endpgm
L_prepw:
    s_waitcnt lgkmcnt(0)
    s_barrier
    s_mov_b64 s[52:53], s[10:11]
    s_mov_b32 s54, 0x380000
    s_mov_b32 s55, 0x20000
    s_cmp_eq_u32 s30, 0
    s_cbranch_scc0 L_nq0
    s_mov_b32 m0, 131072
    s_nop 0
    buffer_load_dwordx4 v240, s[52:55], s50 offen nt lds
    s_add_u32 s50, s50, 65536
    s_mov_b32 m0, 132096
    s_nop 0
    buffer_load_dwordx4 v240, s[52:55], s50 offen nt lds
    s_add_u32 s50, s50, 65536
    s_mov_b32 m0, 133120
    s_nop 0
    buffer_load_dwordx4 v240, s[52:55], s50 offen nt lds
    s_add_u32 s50, s50, 65536
    s_mov_b32 m0, 134144
    s_nop 0
    buffer_load_dwordx4 v240, s[52:55], s50 offen nt lds
    s_add_u32 s50, s50, 65536
    s_mov_b32 m0, 135168
    s_nop 0
    buffer_load_dwordx4 v240, s[52:55], s50 offen nt lds
    s_add_u32 s50, s50, 65536
    s_mov_b32 m0, 136192
    s_nop 0
    buffer_load_dwordx4 v240, s[52:55], s50 offen nt lds
    s_add_u32 s50, s50, 65536
    s_mov_b32 m0, 137216
    s_nop 0
    buffer_load_dwordx4 v240, s[52:55], s50 offen nt lds
    s_add_u32 s50, s50, 65536
    s_mov_b32 m0, 138240
    s_nop 0
    buffer_load_dwordx4 v240, s[52:55], s50 offen nt lds
    s_add_u32 s50, s50, 65536
    s_mov_b32 m0, 139264
    s_nop 0
    buffer_load_dwordx4 v240, s[52:55], s50 offen nt lds
    s_add_u32 s50, s50, 65536
    s_mov_b32 m0, 140288
    s_nop 0
    buffer_load_dwordx4 v240, s[52:55], s50 offen nt lds
    s_add_u32 s50, s50, 65536
    s_mov_b32 m0, 141312
    s_nop 0
    buffer_load_dwordx4 v240, s[52:55], s50 offen nt lds
    s_add_u32 s50, s50, 65536
    s_mov_b32 m0, 142336
    s_nop 0
    buffer_load_dwordx4 v240, s[52:55], s50 offen nt lds
    s_add_u32 s50, s50, 65536
    s_mov_b32 m0, 143360
    s_nop 0
    buffer_load_dwordx4 v240, s[52:55], s50 offen nt lds
    s_add_u32 s50, s50, 65536
    s_mov_b32 m0, 144384
    s_nop 0
    buffer_load_dwordx4 v240, s[52:55], s50 offen nt lds
    s_add_u32 s50, s50, 65536
L_nq0:
    s_cmp_eq_u32 s46, 0
    s_cbranch_scc1 L_nolead
    s_waitcnt vmcnt(0)
    s_atomic_add s46, s[26:27], s63
L_nolead:
    s_mov_b32 s49, 0
    s_bfe_u32 s34, s32, 0x10001
    s_lshl1_add_u32 s33, s31, s34
    s_lshl2_add_u32 s33, s33, s30
    s_lshl_b32 s33, s33, 6
    s_mul_i32 s33, s33, 896
    s_lshr_b32 s34, s32, 2
    s_min_u32 s34, s34, 6
    s_lshl_b32 s34, s34, 7
    s_add_u32 s51, s33, s34
    v_lshrrev_b32 v224, 3, v0
    v_mul_u32_u24 v224, 896, v224
    v_and_b32 v184, 16, v0
    v_lshlrev_b32 v184, 1, v184
    v_and_b32 v185, 0x70, v3
    v_xor_b32 v184, v184, v185
    v_xor_b32 v185, 64, v184
    v_add_u32 v225, v224, v185
    v_add_u32 v224, v224, v184
    v_lshrrev_b32 v184, 2, v1
    v_lshl_add_u32 v184, v2, 3, v184
    v_lshlrev_b32 v184, 7, v184
    v_bfe_u32 v185, v0, 3, 2
    v_lshl_add_u32 v184, v185, 5, v184
    v_and_b32 v185, 3, v0
    v_lshl_add_u32 v184, v185, 3, v184
    s_lshl_b32 s61, s30, 13
    v_add_u32 v241, s61, v184
    s_xor_b32 s34, s32, 16
    s_and_b32 s35, s34, 3
    s_lshr_b32 s34, s34, 2
    s_lshl3_add_u32 s34, s35, s34
    s_lshl_b32 s34, s34, 7
    s_lshl_b32 s39, s31, 15
    s_add_u32 s34, s34, s39
    v_and_b32 v237, 7, v1
    v_lshlrev_b32 v237, 12, v237
    v_lshl_add_u32 v237, v2, 4, v237
    v_add_u32 v237, s34, v237
    s_lshl_b32 s33, s31, 15
    s_mul_i32 s34, s30, 224
    s_add_u32 s33, s33, s34
    s_add_u32 s33, s33, 524288
    v_min_u32 v184, 13, v1
    v_mul_u32_u24 v233, 3584, v2
    v_lshl_add_u32 v233, v184, 4, v233
    v_add_u32 v233, s33, v233
    v_lshrrev_b32 v185, 1, v2
    v_mul_u32_u24 v185, 9216, v185
    v_add_u32 v233, v233, v185
    v_cmp_gt_u32 s[42:43], 14, v1
    v_lshrrev_b32 v186, 5, v0
    s_lshl_b32 s34, s30, 3
    s_add_u32 s34, s34, 161024
    v_lshlrev_b32 v234, 2, v186
    v_add_u32 v234, s34, v234
    v_cvt_f32_u32 v220, v186
    v_sub_f32 v222, 1.0, v220
    v_mul_f32 v220, 0x3b124925, v220
    v_mul_f32 v222, 0x3b124925, v222
    v_and_b32 v188, 16, v3
    v_mov_b32 v189, 0x3f80
    v_lshlrev_b32 v189, v188, v189
    v_bfe_u32 v188, v1, 1, 2
    v_cmp_eq_u32 vcc, 0, v188
    s_nop 1
    v_cndmask_b32 v208, 0, v189, vcc
    v_cmp_eq_u32 vcc, 1, v188
    s_nop 1
    v_cndmask_b32 v209, 0, v189, vcc
    v_cmp_eq_u32 vcc, 2, v188
    s_nop 1
    v_cndmask_b32 v210, 0, v189, vcc
    v_cmp_eq_u32 vcc, 3, v188
    s_nop 1
    v_cndmask_b32 v211, 0, v189, vcc
    s_mul_i32 s33, s31, 896
    s_mul_i32 s34, s30, 224
    s_add_u32 s33, s33, s34
    v_and_b32 v185, 1, v2
    v_lshlrev_b32 v244, 4, v184
    v_lshl_add_u32 v244, v185, 3, v244
    v_add_u32 v244, s33, v244
    v_lshl_add_u32 v235, v186, 2, v244
    s_lshl_b32 s34, s30, 7
    s_add_u32 s34, s34, 158976
    v_lshlrev_b32 v242, 3, v185
    v_lshl_add_u32 v242, v186, 2, v242
    v_add_u32 v242, s34, v242
    s_lshl_b32 s33, s31, 5
    s_add_u32 s33, s33, s32
    s_mul_i32 s34, s33, 48
    s_add_u32 s34, s34, 851968
    v_lshlrev_b32 v243, 2, v1
    v_add_u32 v243, s34, v243
    s_mul_i32 s96, s33, 786432
    s_add_u32 s96, s96, 905969664
    s_xor_b32 s97, s96, 0x80000000
    s_lshl_b32 s33, s31, 8
    s_add_u32 s33, s33, 786432
    s_and_b32 s34, s32, 3
    s_lshl_b32 s34, s34, 6
    s_add_u32 s34, s34, s33
    v_lshlrev_b32 v226, 4, v2
    v_add_u32 v226, s34, v226
    s_lshl2_add_u32 s34, s32, s33
    v_lshlrev_b32 v231, 7, v0
    v_add_u32 v231, s34, v231
    s_add_u32 s33, s39, 262144
    s_and_b32 s35, s32, 1
    s_bfe_u32 s36, s32, 0x10001
    s_lshl1_add_u32 s34, s35, s36
    s_lshl2_add_u32 s34, s34, s30
    s_lshl_b32 s34, s34, 11
    s_add_u32 s34, s34, s33
    v_add_u32 v227, s34, v3
    s_lshl2_add_u32 s60, s35, s30
    s_lshl1_add_u32 s34, s31, s36
    s_mul_i32 s34, s34, 896
    s_lshl_b32 s36, s60, 15
    s_add_u32 s34, s34, s36
    s_cmp_ge_u32 s31, 4
    s_cselect_b32 s36, 9216, 0
    s_add_u32 s34, s34, s36
    s_lshr_b32 s36, s32, 2
    s_min_u32 s36, s36, 6
    s_lshl_b32 s36, s36, 7
    s_add_u32 s34, s34, s36
    s_add_u32 s34, s34, 524288
    v_and_b32 v229, 31, v0
    v_lshlrev_b32 v229, 2, v229
    v_add_u32 v229, s34, v229
    s_lshr_b32 s34, s32, 4
    s_lshl2_add_u32 s34, s34, s30
    s_lshl_b32 s34, s34, 12
    s_add_u32 s34, s34, s33
    s_and_b32 s36, s32, 15
    s_lshl4_add_u32 s34, s36, s34
    v_lshrrev_b32 v230, 2, v0
    v_lshlrev_b32 v230, 8, v230
    v_and_b32 v184, 3, v0
    v_lshl_add_u32 v230, v184, 2, v230
    v_add_u32 v230, s34, v230
    s_lshl_b32 s34, s30, 8
    s_add_u32 s34, s34, 154880
    v_and_b32 v239, 31, v0
    v_lshlrev_b32 v239, 3, v239
    v_add_u32 v239, s34, v239
    s_lshl_b32 s34, s30, 9
    s_add_u32 s34, s34, 146688
    v_lshlrev_b32 v238, 3, v0
    v_add_u32 v238, s34, v238
    s_lshl_b32 s34, s30, 10
    s_add_u32 s34, s34, 154880
    v_lshlrev_b32 v228, 2, v1
    v_lshl_add_u32 v228, v2, 8, v228
    v_add_u32 v228, s34, v228
    s_mov_b32 s38, 0xffff0000
    s_barrier
    s_mul_i32 s33, s30, 896
    v_mul_u32_u24 v194, 14, v0
    v_and_b32 v194, -4, v194
    v_add_u32 v194, s33, v194
    global_load_dwordx4 v[96:99], v194, s[16:17]
    global_load_dwordx4 v[100:103], v194, s[18:19]
    global_load_dwordx4 v[104:107], v194, s[20:21]
    v_mov_b32 v196, 0
    global_load_ushort v236, v196, s[22:23]
    s_cmp_eq_u32 s30, 0
    s_cbranch_scc0 L_nopub
    s_mov_b32 s34, 0x3f803f80
    v_mov_b32 v124, s34
    v_mov_b32 v125, s34
    v_mov_b32 v126, s34
    v_mov_b32 v127, s34
    v_mov_b32 v128, s34
    v_mov_b32 v129, s34
    v_mov_b32 v130, s34
    v_mov_b32 v131, s34
    v_mov_b32 v132, s34
    v_mov_b32 v133, s34
    v_mov_b32 v134, s34
    v_mov_b32 v135, s34
    v_mov_b32 v136, s34
    v_mov_b32 v137, s34
    v_mov_b32 v138, s34
    v_mov_b32 v139, s34
    v_mov_b32 v140, s34
    v_mov_b32 v141, s34
    v_mov_b32 v142, s34
    v_mov_b32 v143, s34
    v_mov_b32 v144, s34
    v_mov_b32 v145, s34
    v_mov_b32 v146, s34
    v_mov_b32 v147, s34
    v_mov_b32 v148, s34
    v_mov_b32 v149, s34
    v_mov_b32 v150, s34
    v_mov_b32 v151, s34
    v_mov_b32 v152, s34
    v_mov_b32 v153, s34
    v_mov_b32 v154, s34
    v_mov_b32 v155, s34
    v_mov_b32 v156, s34
    v_mov_b32 v157, s34
    v_mov_b32 v158, s34
    v_mov_b32 v159, s34
    v_mov_b32 v160, s34
    v_mov_b32 v161, s34
    v_mov_b32 v162, s34
    v_mov_b32 v163, s34
    v_mov_b32 v164, s34
    v_mov_b32 v165, s34
    v_mov_b32 v166, s34
    v_mov_b32 v167, s34
    v_mov_b32 v168, s34
    v_mov_b32 v169, s34
    v_mov_b32 v170, s34
    v_mov_b32 v171, s34
    v_mov_b32 v172, s34
    v_mov_b32 v173, s34
    v_mov_b32 v174, s34
    v_mov_b32 v175, s34
    v_mov_b32 v176, s34
    v_mov_b32 v177, s34
    v_mov_b32 v178, s34
    v_mov_b32 v179, s34
    v_and_b32 v181, 7, v1
    v_mul_u32_u24 v181, 896, v181
    v_add_u32 v181, 146688, v181
    v_lshl_add_u32 v180, v2, 4, v181
    s_mul_i32 s33, s48, 224
    v_lshl_add_u32 v181, v2, 3, v181
    v_add_u32 v181, s33, v181
    v_lshrrev_b32 v182, 2, v0
    v_lshlrev_b32 v182, 7, v182
    v_and_or_b32 v182, v3, 48, v182
    v_add_u32 v182, 131072, v182
    v_bfe_u32 v183, v1, 2, 1
    v_lshl_add_u32 v183, v183, 4, v1
    v_lshlrev_b32 v183, 2, v183
    v_lshlrev_b32 v184, 2, v1
    v_add_u32 v184, 128, v184
    v_and_b32 v185, 3, v1
    v_cmp_eq_u32 s[6:7], 1, v185
    v_cmp_eq_u32 s[8:9], 2, v185
    v_cmp_eq_u32 s[14:15], 3, v185
    s_mov_b32 exec_lo, 0x00ff00ff
    s_mov_b32 exec_hi, 0x00ff00ff
    s_waitcnt vmcnt(18)
    ds_read_b128 v[124:127], v180 offset:0
    ds_read_b128 v[128:131], v180 offset:64
    ds_read_b128 v[132:135], v180 offset:128
    ds_read_b128 v[136:139], v180 offset:192
    ds_read_b128 v[140:143], v180 offset:256
    ds_read_b128 v[144:147], v180 offset:320
    ds_read_b128 v[148:151], v180 offset:384
    ds_read_b128 v[152:155], v180 offset:448
    ds_read_b128 v[156:159], v180 offset:512
    ds_read_b128 v[160:163], v180 offset:576
    ds_read_b128 v[164:167], v180 offset:640
    ds_read_b128 v[168:171], v180 offset:704
    ds_read_b128 v[172:175], v180 offset:768
    ds_read_b128 v[176:179], v180 offset:832
    s_mov_b64 exec, -1
    s_waitcnt lgkmcnt(13)
    v_mfma_f32_16x16x32_bf16 v[188:191], v[124:127], v[124:127], 0
    s_waitcnt lgkmcnt(12)
    v_mfma_f32_16x16x32_bf16 v[188:191], v[128:131], v[128:131], v[188:191]
    s_waitcnt lgkmcnt(11)
    v_mfma_f32_16x16x32_bf16 v[188:191], v[132:135], v[132:135], v[188:191]
    s_waitcnt lgkmcnt(10)
    v_mfma_f32_16x16x32_bf16 v[188:191], v[136:139], v[136:139], v[188:191]
    s_waitcnt lgkmcnt(9)
    v_mfma_f32_16x16x32_bf16 v[188:191], v[140:143], v[140:143], v[188:191]
    s_waitcnt lgkmcnt(8)
    v_mfma_f32_16x16x32_bf16 v[188:191], v[144:147], v[144:147], v[188:191]
    s_waitcnt lgkmcnt(7)
    v_mfma_f32_16x16x32_bf16 v[188:191], v[148:151], v[148:151], v[188:191]
    s_waitcnt lgkmcnt(6)
    v_mfma_f32_16x16x32_bf16 v[188:191], v[152:155], v[152:155], v[188:191]
    s_waitcnt lgkmcnt(5)
    v_mfma_f32_16x16x32_bf16 v[188:191], v[156:159], v[156:159], v[188:191]
    s_waitcnt lgkmcnt(4)
    v_mfma_f32_16x16x32_bf16 v[188:191], v[160:163], v[160:163], v[188:191]
    s_waitcnt lgkmcnt(3)
    v_mfma_f32_16x16x32_bf16 v[188:191], v[164:167], v[164:167], v[188:191]
    s_waitcnt lgkmcnt(2)
    v_mfma_f32_16x16x32_bf16 v[188:191], v[168:171], v[168:171], v[188:191]
    s_waitcnt lgkmcnt(1)
    v_mfma_f32_16x16x32_bf16 v[188:191], v[172:175], v[172:175], v[188:191]
    s_waitcnt lgkmcnt(0)
    v_mfma_f32_16x16x32_bf16 v[188:191], v[176:179], v[176:179], v[188:191]
    s_nop 7
    v_cndmask_b32 v188, v188, v189, s[6:7]
    v_cndmask_b32 v188, v188, v190, s[8:9]
    v_cndmask_b32 v188, v188, v191, s[14:15]
    ds_bpermute_b32 v186, v183, v188
    ds_bpermute_b32 v187, v184, v188
    s_mov_b32 exec_lo, 0x00ff00ff
    s_mov_b32 exec_hi, 0x00ff00ff
    ds_read_b64 v[124:125], v181 offset:0
    ds_read_b64 v[126:127], v181 offset:32
    ds_read_b64 v[128:129], v181 offset:64
    ds_read_b64 v[130:131], v181 offset:96
    ds_read_b64 v[132:133], v181 offset:128
    ds_read_b64 v[134:135], v181 offset:160
    ds_read_b64 v[136:137], v181 offset:192
    s_mov_b64 exec, -1
    s_mov_b32 s33, 0x3b124925
    s_waitcnt lgkmcnt(0)
    v_mul_f32 v187, s33, v187
    v_mul_f32 v186, s33, v186
    v_fma_f32 v186, -v187, v187, v186
    v_max_f32 v186, 0, v186
    v_add_f32 v186, 0x3727c5ac, v186
    v_rsq_f32 v186, v186
    s_waitcnt vmcnt(4)
    ds_read_b64_tr_b16 v[60:61], v182 offset:0
    ds_read_b64_tr_b16 v[62:63], v182 offset:8
    ds_read_b64_tr_b16 v[64:65], v182 offset:2048
    ds_read_b64_tr_b16 v[66:67], v182 offset:2056
    ds_read_b64_tr_b16 v[68:69], v182 offset:4096
    ds_read_b64_tr_b16 v[70:71], v182 offset:4104
    ds_read_b64_tr_b16 v[72:73], v182 offset:6144
    ds_read_b64_tr_b16 v[74:75], v182 offset:6152
    ds_read_b64_tr_b16 v[76:77], v182 offset:8192
    ds_read_b64_tr_b16 v[78:79], v182 offset:8200
    ds_read_b64_tr_b16 v[80:81], v182 offset:10240
    ds_read_b64_tr_b16 v[82:83], v182 offset:10248
    ds_read_b64_tr_b16 v[84:85], v182 offset:12288
    ds_read_b64_tr_b16 v[86:87], v182 offset:12296
    s_waitcnt lgkmcnt(12)
    v_mfma_f32_16x16x16_bf16 v[140:143], v[60:61], v[124:125], 0
    v_mfma_f32_16x16x16_bf16 v[144:147], v[62:63], v[124:125], 0
    s_waitcnt lgkmcnt(10)
    v_mfma_f32_16x16x16_bf16 v[140:143], v[64:65], v[126:127], v[140:143]
    v_mfma_f32_16x16x16_bf16 v[144:147], v[66:67], v[126:127], v[144:147]
    s_waitcnt lgkmcnt(8)
    v_mfma_f32_16x16x16_bf16 v[140:143], v[68:69], v[128:129], v[140:143]
    v_mfma_f32_16x16x16_bf16 v[144:147], v[70:71], v[128:129], v[144:147]
    s_waitcnt lgkmcnt(6)
    v_mfma_f32_16x16x16_bf16 v[140:143], v[72:73], v[130:131], v[140:143]
    v_mfma_f32_16x16x16_bf16 v[144:147], v[74:75], v[130:131], v[144:147]
    s_waitcnt lgkmcnt(4)
    v_mfma_f32_16x16x16_bf16 v[140:143], v[76:77], v[132:133], v[140:143]
    v_mfma_f32_16x16x16_bf16 v[144:147], v[78:79], v[132:133], v[144:147]
    s_waitcnt lgkmcnt(2)
    v_mfma_f32_16x16x16_bf16 v[140:143], v[80:81], v[134:135], v[140:143]
    v_mfma_f32_16x16x16_bf16 v[144:147], v[82:83], v[134:135], v[144:147]
    s_waitcnt lgkmcnt(0)
    v_mfma_f32_16x16x16_bf16 v[140:143], v[84:85], v[136:137], v[140:143]
    v_mfma_f32_16x16x16_bf16 v[144:147], v[86:87], v[136:137], v[144:147]
    ds_read_b64_tr_b16 v[60:61], v182 offset:64
    ds_read_b64_tr_b16 v[62:63], v182 offset:72
    ds_read_b64_tr_b16 v[64:65], v182 offset:2112
    ds_read_b64_tr_b16 v[66:67], v182 offset:2120
    ds_read_b64_tr_b16 v[68:69], v182 offset:4160
    ds_read_b64_tr_b16 v[70:71], v182 offset:4168
    ds_read_b64_tr_b16 v[72:73], v182 offset:6208
    ds_read_b64_tr_b16 v[74:75], v182 offset:6216
    ds_read_b64_tr_b16 v[76:77], v182 offset:8256
    ds_read_b64_tr_b16 v[78:79], v182 offset:8264
    ds_read_b64_tr_b16 v[80:81], v182 offset:10304
    ds_read_b64_tr_b16 v[82:83], v182 offset:10312
    ds_read_b64_tr_b16 v[84:85], v182 offset:12352
    ds_read_b64_tr_b16 v[86:87], v182 offset:12360
    s_waitcnt lgkmcnt(12)
    v_mfma_f32_16x16x16_bf16 v[148:151], v[60:61], v[124:125], 0
    v_mfma_f32_16x16x16_bf16 v[152:155], v[62:63], v[124:125], 0
    s_waitcnt lgkmcnt(10)
    v_mfma_f32_16x16x16_bf16 v[148:151], v[64:65], v[126:127], v[148:151]
    v_mfma_f32_16x16x16_bf16 v[152:155], v[66:67], v[126:127], v[152:155]
    s_waitcnt lgkmcnt(8)
    v_mfma_f32_16x16x16_bf16 v[148:151], v[68:69], v[128:129], v[148:151]
    v_mfma_f32_16x16x16_bf16 v[152:155], v[70:71], v[128:129], v[152:155]
    s_waitcnt lgkmcnt(6)
    v_mfma_f32_16x16x16_bf16 v[148:151], v[72:73], v[130:131], v[148:151]
    v_mfma_f32_16x16x16_bf16 v[152:155], v[74:75], v[130:131], v[152:155]
    s_waitcnt lgkmcnt(4)
    v_mfma_f32_16x16x16_bf16 v[148:151], v[76:77], v[132:133], v[148:151]
    v_mfma_f32_16x16x16_bf16 v[152:155], v[78:79], v[132:133], v[152:155]
    s_waitcnt lgkmcnt(2)
    v_mfma_f32_16x16x16_bf16 v[148:151], v[80:81], v[134:135], v[148:151]
    v_mfma_f32_16x16x16_bf16 v[152:155], v[82:83], v[134:135], v[152:155]
    s_waitcnt lgkmcnt(0)
    v_mfma_f32_16x16x16_bf16 v[148:151], v[84:85], v[136:137], v[148:151]
    v_mfma_f32_16x16x16_bf16 v[152:155], v[86:87], v[136:137], v[152:155]
    s_load_dword s46, s[26:27], s63
    v_mul_f32_dpp v188, v140, v187 row_newbcast:8 row_mask:0xf bank_mask:0xf
    v_mul_f32_dpp v189, v141, v187 row_newbcast:8 row_mask:0xf bank_mask:0xf
    v_mul_f32_dpp v190, v142, v187 row_newbcast:8 row_mask:0xf bank_mask:0xf
    v_mul_f32_dpp v191, v143, v187 row_newbcast:8 row_mask:0xf bank_mask:0xf
    v_mul_f32_dpp v192, v144, v187 row_newbcast:8 row_mask:0xf bank_mask:0xf
    v_mul_f32_dpp v193, v145, v187 row_newbcast:8 row_mask:0xf bank_mask:0xf
    v_mul_f32_dpp v194, v146, v187 row_newbcast:8 row_mask:0xf bank_mask:0xf
    v_mul_f32_dpp v195, v147, v187 row_newbcast:8 row_mask:0xf bank_mask:0xf
    v_sub_f32 v188, v140, v188
    v_mul_f32 v188, v188, v186
    v_sub_f32 v189, v141, v189
    v_mul_f32 v189, v189, v186
    v_sub_f32 v190, v142, v190
    v_mul_f32 v190, v190, v186
    v_sub_f32 v191, v143, v191
    v_mul_f32 v191, v191, v186
    v_sub_f32 v192, v144, v192
    v_mul_f32 v192, v192, v186
    v_sub_f32 v193, v145, v193
    v_mul_f32 v193, v193, v186
    v_sub_f32 v194, v146, v194
    v_mul_f32 v194, v194, v186
    v_sub_f32 v195, v147, v195
    v_mul_f32 v195, v195, v186
    v_cvt_pk_bf16_f32 v212, v188, v189
    v_min_u32 v212, -2, v212
    v_cvt_pk_bf16_f32 v213, v190, v191
    v_min_u32 v213, -2, v213
    v_cvt_pk_bf16_f32 v214, v192, v193
    v_min_u32 v214, -2, v214
    v_cvt_pk_bf16_f32 v215, v194, v195
    v_min_u32 v215, -2, v215
    v_mul_f32_dpp v188, v148, v187 row_newbcast:8 row_mask:0xf bank_mask:0xf
    v_mul_f32_dpp v189, v149, v187 row_newbcast:8 row_mask:0xf bank_mask:0xf
    v_mul_f32_dpp v190, v150, v187 row_newbcast:8 row_mask:0xf bank_mask:0xf
    v_mul_f32_dpp v191, v151, v187 row_newbcast:8 row_mask:0xf bank_mask:0xf
    v_mul_f32_dpp v192, v152, v187 row_newbcast:8 row_mask:0xf bank_mask:0xf
    v_mul_f32_dpp v193, v153, v187 row_newbcast:8 row_mask:0xf bank_mask:0xf
    v_mul_f32_dpp v194, v154, v187 row_newbcast:8 row_mask:0xf bank_mask:0xf
    v_mul_f32_dpp v195, v155, v187 row_newbcast:8 row_mask:0xf bank_mask:0xf
    v_sub_f32 v188, v148, v188
    v_mul_f32 v188, v188, v186
    v_sub_f32 v189, v149, v189
    v_mul_f32 v189, v189, v186
    v_sub_f32 v190, v150, v190
    v_mul_f32 v190, v190, v186
    v_sub_f32 v191, v151, v191
    v_mul_f32 v191, v191, v186
    v_sub_f32 v192, v152, v192
    v_mul_f32 v192, v192, v186
    v_sub_f32 v193, v153, v193
    v_mul_f32 v193, v193, v186
    v_sub_f32 v194, v154, v194
    v_mul_f32 v194, v194, v186
    v_sub_f32 v195, v155, v195
    v_mul_f32 v195, v195, v186
    v_cvt_pk_bf16_f32 v216, v188, v189
    v_min_u32 v216, -2, v216
    v_cvt_pk_bf16_f32 v217, v190, v191
    v_min_u32 v217, -2, v217
    v_cvt_pk_bf16_f32 v218, v192, v193
    v_min_u32 v218, -2, v218
    v_cvt_pk_bf16_f32 v219, v194, v195
    v_min_u32 v219, -2, v219
    s_getreg_b32 s47, hwreg(HW_REG_XCC_ID, 0, 4)
    s_mul_i32 s47, s47, 0x1111
    s_bitset1_b32 s47, 18
    s_waitcnt lgkmcnt(0)
    s_cmp_eq_u32 s46, s47
    s_cbranch_scc0 L_f1slow
L_same:
    s_mov_b32 s41, s46
    s_mov_b32 exec_lo, 0x00ff00ff
    s_mov_b32 exec_hi, 0x00ff00ff
    global_store_dwordx4 v237, v[212:215], s[28:29] offset:0
    global_store_dwordx4 v237, v[216:219], s[28:29] offset:64
    s_mov_b64 exec, -1
L_nopub:
    s_cmp_eq_u32 s30, 0
    s_cselect_b32 s33, s49, 1
    s_cmp_eq_u32 s33, 0
    s_cbranch_scc1 L_pw
    s_waitcnt vmcnt(0)
L_pw:
    s_waitcnt vmcnt(2)
    v_and_b32 v184, 16, v3
    v_alignbit_b32 v96, v97, v96, v184
    v_alignbit_b32 v97, v98, v97, v184
    v_alignbit_b32 v98, v99, v98, v184
    v_lshrrev_b32 v99, v184, v99
    v_lshlrev_b32 v4, 16, v96
    v_and_b32 v6, s38, v96
    v_lshlrev_b32 v8, 16, v97
    v_and_b32 v10, s38, v97
    v_lshlrev_b32 v12, 16, v98
    v_and_b32 v14, s38, v98
    v_lshlrev_b32 v16, 16, v99
    v_alignbit_b32 v100, v101, v100, v184
    v_alignbit_b32 v101, v102, v101, v184
    v_alignbit_b32 v102, v103, v102, v184
    v_lshrrev_b32 v103, v184, v103
    v_lshlrev_b32 v18, 16, v100
    v_and_b32 v20, s38, v100
    v_lshlrev_b32 v22, 16, v101
    v_and_b32 v24, s38, v101
    v_lshlrev_b32 v26, 16, v102
    v_and_b32 v28, s38, v102
    v_lshlrev_b32 v30, 16, v103
    v_alignbit_b32 v104, v105, v104, v184
    v_alignbit_b32 v105, v106, v105, v184
    v_alignbit_b32 v106, v107, v106, v184
    v_lshrrev_b32 v107, v184, v107
    v_lshlrev_b32 v32, 16, v104
    v_and_b32 v34, s38, v104
    v_lshlrev_b32 v36, 16, v105
    v_and_b32 v38, s38, v105
    v_lshlrev_b32 v40, 16, v106
    v_and_b32 v42, s38, v106
    v_lshlrev_b32 v44, 16, v107
    v_mov_b32 v46, 0xbdd2d3e8
    v_mov_b32 v48, 0xc0135761
    v_lshlrev_b32 v236, 16, v236
    s_mov_b32 s98, 4
    s_call_b64 s[100:101], L_tab
L_nt1:
    s_lshr_b32 s33, s32, 2
    s_lshl_b32 s33, s33, 12
    s_add_u32 s33, s33, s39
    v_add_u32 v180, s33, v3
    v_add_u32 v181, 145408, v3
    v_and_b32 v200, 7, v0
    v_lshlrev_b32 v200, 2, v200
    v_mov_b32 v199, 146496
    s_cmp_eq_u32 s30, 0
    s_cselect_b32 s33, s49, 1
    s_cmp_eq_u32 s33, 0
    s_barrier
    s_cbranch_scc0 L_nqi
    global_load_dwordx4 v[124:127], v180, s[28:29] offset:0 sc1
    global_load_dwordx4 v[128:131], v180, s[28:29] offset:1024 sc1
    global_load_dwordx4 v[132:135], v180, s[28:29] offset:2048 sc1
    global_load_dwordx4 v[136:139], v180, s[28:29] offset:3072 sc1
L_nqi:
    s_mov_b32 s98, 2
    s_call_b64 s[100:101], L_tab
L_nt2:
    s_mov_b32 s35, 0
    s_cmp_eq_u32 s30, 0
    s_cbranch_scc0 L_b1b
    s_cmp_eq_u32 s49, 0
    s_cbranch_scc0 L_glob
L_qchk:
    s_waitcnt vmcnt(0)
    v_max3_u32 v182, v124, v125, v126
    v_max3_u32 v182, v182, v127, v128
    v_max3_u32 v182, v182, v129, v130
    v_max3_u32 v182, v182, v131, v132
    v_max3_u32 v182, v182, v133, v134
    v_max3_u32 v182, v182, v135, v136
    v_max3_u32 v182, v182, v137, v138
    v_max_u32 v182, v182, v139
    v_cmp_eq_u32 vcc, -1, v182
    s_nop 0
    s_cbranch_vccnz L_qretry
L_qdone:
    v_lshlrev_b32 v184, 16, v124
    v_and_b32 v185, s38, v124
    v_lshlrev_b32 v186, 16, v128
    v_and_b32 v187, s38, v128
    v_lshlrev_b32 v188, 16, v132
    v_and_b32 v189, s38, v132
    v_lshlrev_b32 v190, 16, v136
    v_and_b32 v191, s38, v136
    v_pk_add_f32 v[184:185], v[184:185], v[186:187]
    v_pk_add_f32 v[188:189], v[188:189], v[190:191]
    v_pk_add_f32 v[184:185], v[184:185], v[188:189]
    v_cvt_pk_bf16_f32 v124, v184, v185
    v_lshlrev_b32 v184, 16, v125
    v_and_b32 v185, s38, v125
    v_lshlrev_b32 v186, 16, v129
    v_and_b32 v187, s38, v129
    v_lshlrev_b32 v188, 16, v133
    v_and_b32 v189, s38, v133
    v_lshlrev_b32 v190, 16, v137
    v_and_b32 v191, s38, v137
    v_pk_add_f32 v[184:185], v[184:185], v[186:187]
    v_pk_add_f32 v[188:189], v[188:189], v[190:191]
    v_pk_add_f32 v[184:185], v[184:185], v[188:189]
    v_cvt_pk_bf16_f32 v125, v184, v185
    v_lshlrev_b32 v184, 16, v126
    v_and_b32 v185, s38, v126
    v_lshlrev_b32 v186, 16, v130
    v_and_b32 v187, s38, v130
    v_lshlrev_b32 v188, 16, v134
    v_and_b32 v189, s38, v134
    v_lshlrev_b32 v190, 16, v138
    v_and_b32 v191, s38, v138
    v_pk_add_f32 v[184:185], v[184:185], v[186:187]
    v_pk_add_f32 v[188:189], v[188:189], v[190:191]
    v_pk_add_f32 v[184:185], v[184:185], v[188:189]
    v_cvt_pk_bf16_f32 v126, v184, v185
    v_lshlrev_b32 v184, 16, v127
    v_and_b32 v185, s38, v127
    v_lshlrev_b32 v186, 16, v131
    v_and_b32 v187, s38, v131
    v_lshlrev_b32 v188, 16, v135
    v_and_b32 v189, s38, v135
    v_lshlrev_b32 v190, 16, v139
    v_and_b32 v191, s38, v139
    v_pk_add_f32 v[184:185], v[184:185], v[186:187]
    v_pk_add_f32 v[188:189], v[188:189], v[190:191]
    v_pk_add_f32 v[184:185], v[184:185], v[188:189]
    v_cvt_pk_bf16_f32 v127, v184, v185
    ds_write_b128 v181, v[124:127]
    v_mov_b32 v182, s49
    ds_write_b32 v199, v182
    s_cmp_eq_u32 s32, 8
    s_cbranch_scc0 L_nof2
    s_mov_b32 s33, 0x100000
    s_waitcnt lgkmcnt(0)
    s_barrier
    s_atomic_add s33, s[26:27], s63
    s_branch L_b1c
L_nof2:
    s_waitcnt lgkmcnt(0)
L_b1b:
    s_barrier
L_b1c:
    ds_read_b32 v201, v199
    s_cmp_eq_u32 s30, 2
    s_cbranch_scc0 L_notp
    v_lshlrev_b32 v188, 3, v1
    v_add_u32 v188, 158976, v188
    ds_read_b64 v[190:191], v188 offset:0
    ds_read_b64 v[192:193], v188 offset:128
    ds_read_b64 v[194:195], v188 offset:256
    ds_read_b64 v[196:197], v188 offset:384
    s_waitcnt lgkmcnt(0)
    v_pk_add_f32 v[190:191], v[190:191], v[192:193]
    v_pk_add_f32 v[190:191], v[190:191], v[194:195]
    v_pk_add_f32 v[190:191], v[190:191], v[196:197]
    v_add_f32 v190, v190, v236
    v_add_f32 v191, v191, v236
    v_cvt_pk_bf16_f32 v190, v190, v191
    v_min_u32 v190, -2, v190
    s_mov_b64 exec, 4095
    global_store_dword v243, v190, s[28:29] sc1
    s_mov_b64 exec, -1
L_notp:
    v_and_b32 v180, 1, v0
    v_lshlrev_b32 v180, 5, v180
    v_add_u32 v180, 146432, v180
    s_barrier
    ds_read_b128 v[184:187], v180
    ds_read_b128 v[188:191], v180 offset:16
    s_waitcnt lgkmcnt(0)
    v_max3_f32 v181, v184, v185, v186
    v_max_f32 v181, v181, v187
    v_sub_f32 v184, v184, v181
    v_sub_f32 v185, v185, v181
    v_sub_f32 v186, v186, v181
    v_sub_f32 v187, v187, v181
    v_exp_f32 v184, v184
    v_exp_f32 v185, v185
    v_exp_f32 v186, v186
    v_exp_f32 v187, v187
    v_mul_f32 v182, v184, v188
    v_fmac_f32 v182, v185, v189
    v_fmac_f32 v182, v186, v190
    v_fmac_f32 v182, v187, v191
    v_log_f32 v182, v182
    s_nop 0
    v_add_f32 v232, v181, v182
    v_min_u32 v232, -2, v232
    v_readfirstlane_b32 s62, v201
    s_nop 0
    s_lshl_b32 s33, s62, 20
    v_add_u32 v226, s33, v226
    v_add_u32 v231, s33, v231
    v_add_u32 v227, s33, v227
    v_add_u32 v230, s33, v230
    s_cmp_eq_u32 s30, 1
    s_cbranch_scc0 L_nolse
    s_mov_b64 exec, 3
    s_cmp_eq_u32 s62, 0
    s_cbranch_scc0 L_slowlse
    global_store_dword v231, v232, s[28:29]
L_lsed:
    s_mov_b64 exec, -1
L_nolse:
    s_mov_b64 s[56:57], s[12:13]
    s_mov_b32 s58, 0x380000
    s_mov_b32 s59, 0x20000
    s_cmp_eq_u32 s60, s31
    s_cselect_b32 s45, 1, 0
    s_andn2_b32 s45, s45, s62
    v_mov_b32 v140, 0
    v_mov_b32 v141, 0
    v_mov_b32 v142, 0
    v_mov_b32 v143, 0
    v_mov_b32 v144, 0
    v_mov_b32 v145, 0
    v_mov_b32 v146, 0
    v_mov_b32 v147, 0
    v_mov_b32 v148, 0
    v_mov_b32 v149, 0
    v_mov_b32 v150, 0
    v_mov_b32 v151, 0
    v_mov_b32 v152, 0
    v_mov_b32 v153, 0
    v_mov_b32 v154, 0
    v_mov_b32 v155, 0
    v_xor_b32 v93, 32, v241
    v_xor_b32 v94, 64, v241
    v_xor_b32 v95, 96, v241
    s_mov_b32 s36, 0x3f800054
    s_brev_b32 s40, 1
    s_brev_b32 s41, 1
    s_branch L_tail
.p2alignl 3, 0xbf810000
L_tab:
    v_pk_fma_f32 v[96:97], s[96:97], v[4:5], v[18:19] op_sel_hi:[1,0,0]
    v_pk_fma_f32 v[98:99], s[96:97], v[6:7], v[20:21] op_sel_hi:[1,0,0]
    v_pk_fma_f32 v[100:101], s[96:97], v[8:9], v[22:23] op_sel_hi:[1,0,0]
    v_pk_fma_f32 v[102:103], s[96:97], v[10:11], v[24:25] op_sel_hi:[1,0,0]
    v_pk_fma_f32 v[104:105], s[96:97], v[12:13], v[26:27] op_sel_hi:[1,0,0]
    v_pk_fma_f32 v[106:107], s[96:97], v[14:15], v[28:29] op_sel_hi:[1,0,0]
    v_pk_fma_f32 v[108:109], s[96:97], v[16:17], v[30:31] op_sel_hi:[1,0,0]
    v_pk_mul_f32 v[110:111], v[96:97], v[96:97]
    v_pk_mul_f32 v[112:113], v[98:99], v[98:99]
    v_pk_mul_f32 v[114:115], v[100:101], v[100:101]
    v_pk_mul_f32 v[116:117], v[102:103], v[102:103]
    v_pk_mul_f32 v[118:119], v[104:105], v[104:105]
    v_pk_mul_f32 v[120:121], v[106:107], v[106:107]
    v_pk_mul_f32 v[122:123], v[108:109], v[108:109]
    v_pk_fma_f32 v[110:111], v[110:111], v[46:47], v[48:49] op_sel_hi:[1,0,0]
    v_pk_fma_f32 v[112:113], v[112:113], v[46:47], v[48:49] op_sel_hi:[1,0,0]
    v_pk_fma_f32 v[114:115], v[114:115], v[46:47], v[48:49] op_sel_hi:[1,0,0]
    v_pk_fma_f32 v[116:117], v[116:117], v[46:47], v[48:49] op_sel_hi:[1,0,0]
    v_pk_fma_f32 v[118:119], v[118:119], v[46:47], v[48:49] op_sel_hi:[1,0,0]
    v_pk_fma_f32 v[120:121], v[120:121], v[46:47], v[48:49] op_sel_hi:[1,0,0]
    v_pk_fma_f32 v[122:123], v[122:123], v[46:47], v[48:49] op_sel_hi:[1,0,0]
    v_pk_mul_f32 v[110:111], v[110:111], v[96:97]
    v_pk_mul_f32 v[112:113], v[112:113], v[98:99]
    v_pk_mul_f32 v[114:115], v[114:115], v[100:101]
    v_pk_mul_f32 v[116:117], v[116:117], v[102:103]
    v_pk_mul_f32 v[118:119], v[118:119], v[104:105]
    v_pk_mul_f32 v[120:121], v[120:121], v[106:107]
    v_pk_mul_f32 v[122:123], v[122:123], v[108:109]
    v_exp_f32 v110, v110
    v_exp_f32 v111, v111
    v_exp_f32 v112, v112
    v_exp_f32 v113, v113
    v_exp_f32 v114, v114
    v_exp_f32 v115, v115
    v_exp_f32 v116, v116
    v_exp_f32 v117, v117
    v_exp_f32 v118, v118
    v_exp_f32 v119, v119
    v_exp_f32 v120, v120
    v_exp_f32 v121, v121
    v_exp_f32 v122, v122
    v_exp_f32 v123, v123
    s_add_u32 s96, s96, 0x10000
    s_add_u32 s97, s97, 0x10000
    v_pk_add_f32 v[110:111], v[110:111], 1.0 op_sel_hi:[1,0]
    v_pk_add_f32 v[112:113], v[112:113], 1.0 op_sel_hi:[1,0]
    v_pk_add_f32 v[114:115], v[114:115], 1.0 op_sel_hi:[1,0]
    v_pk_add_f32 v[116:117], v[116:117], 1.0 op_sel_hi:[1,0]
    v_pk_add_f32 v[118:119], v[118:119], 1.0 op_sel_hi:[1,0]
    v_pk_add_f32 v[120:121], v[120:121], 1.0 op_sel_hi:[1,0]
    v_pk_add_f32 v[122:123], v[122:123], 1.0 op_sel_hi:[1,0]
    v_rcp_f32 v110, v110
    v_rcp_f32 v111, v111
    v_rcp_f32 v112, v112
    v_rcp_f32 v113, v113
    v_rcp_f32 v114, v114
    v_rcp_f32 v115, v115
    v_rcp_f32 v116, v116
    v_rcp_f32 v117, v117
    v_rcp_f32 v118, v118
    v_rcp_f32 v119, v119
    v_rcp_f32 v120, v120
    v_rcp_f32 v121, v121
    v_rcp_f32 v122, v122
    v_rcp_f32 v123, v123
    v_pk_mul_f32 v[96:97], v[96:97], v[110:111]
    v_pk_mul_f32 v[98:99], v[98:99], v[112:113]
    v_pk_mul_f32 v[100:101], v[100:101], v[114:115]
    v_pk_mul_f32 v[102:103], v[102:103], v[116:117]
    v_pk_mul_f32 v[104:105], v[104:105], v[118:119]
    v_pk_mul_f32 v[106:107], v[106:107], v[120:121]
    v_pk_mul_f32 v[108:109], v[108:109], v[122:123]
    v_pk_mul_f32 v[50:51], v[96:97], v[32:33] op_sel_hi:[1,0]
    v_pk_fma_f32 v[50:51], v[98:99], v[34:35], v[50:51] op_sel_hi:[1,0,1]
    v_pk_fma_f32 v[50:51], v[100:101], v[36:37], v[50:51] op_sel_hi:[1,0,1]
    v_pk_fma_f32 v[50:51], v[102:103], v[38:39], v[50:51] op_sel_hi:[1,0,1]
    v_pk_fma_f32 v[50:51], v[104:105], v[40:41], v[50:51] op_sel_hi:[1,0,1]
    v_pk_fma_f32 v[50:51], v[106:107], v[42:43], v[50:51] op_sel_hi:[1,0,1]
    v_pk_fma_f32 v[50:51], v[108:109], v[44:45], v[50:51] op_sel_hi:[1,0,1]
    v_pk_fma_f32 v[96:97], s[96:97], v[4:5], v[18:19] op_sel_hi:[1,0,0]
    v_pk_fma_f32 v[98:99], s[96:97], v[6:7], v[20:21] op_sel_hi:[1,0,0]
    v_pk_fma_f32 v[100:101], s[96:97], v[8:9], v[22:23] op_sel_hi:[1,0,0]
    v_pk_fma_f32 v[102:103], s[96:97], v[10:11], v[24:25] op_sel_hi:[1,0,0]
    v_pk_fma_f32 v[104:105], s[96:97], v[12:13], v[26:27] op_sel_hi:[1,0,0]
    v_pk_fma_f32 v[106:107], s[96:97], v[14:15], v[28:29] op_sel_hi:[1,0,0]
    v_pk_fma_f32 v[108:109], s[96:97], v[16:17], v[30:31] op_sel_hi:[1,0,0]
    v_pk_mul_f32 v[110:111], v[96:97], v[96:97]
    v_pk_mul_f32 v[112:113], v[98:99], v[98:99]
    v_pk_mul_f32 v[114:115], v[100:101], v[100:101]
    v_pk_mul_f32 v[116:117], v[102:103], v[102:103]
    v_pk_mul_f32 v[118:119], v[104:105], v[104:105]
    v_pk_mul_f32 v[120:121], v[106:107], v[106:107]
    v_pk_mul_f32 v[122:123], v[108:109], v[108:109]
    v_pk_fma_f32 v[110:111], v[110:111], v[46:47], v[48:49] op_sel_hi:[1,0,0]
    v_pk_fma_f32 v[112:113], v[112:113], v[46:47], v[48:49] op_sel_hi:[1,0,0]
    v_pk_fma_f32 v[114:115], v[114:115], v[46:47], v[48:49] op_sel_hi:[1,0,0]
    v_pk_fma_f32 v[116:117], v[116:117], v[46:47], v[48:49] op_sel_hi:[1,0,0]
    v_pk_fma_f32 v[118:119], v[118:119], v[46:47], v[48:49] op_sel_hi:[1,0,0]
    v_pk_fma_f32 v[120:121], v[120:121], v[46:47], v[48:49] op_sel_hi:[1,0,0]
    v_pk_fma_f32 v[122:123], v[122:123], v[46:47], v[48:49] op_sel_hi:[1,0,0]
    v_pk_mul_f32 v[110:111], v[110:111], v[96:97]
    v_pk_mul_f32 v[112:113], v[112:113], v[98:99]
    v_pk_mul_f32 v[114:115], v[114:115], v[100:101]
    v_pk_mul_f32 v[116:117], v[116:117], v[102:103]
    v_pk_mul_f32 v[118:119], v[118:119], v[104:105]
    v_pk_mul_f32 v[120:121], v[120:121], v[106:107]
    v_pk_mul_f32 v[122:123], v[122:123], v[108:109]
    v_exp_f32 v110, v110
    v_exp_f32 v111, v111
    v_exp_f32 v112, v112
    v_exp_f32 v113, v113
    v_exp_f32 v114, v114
    v_exp_f32 v115, v115
    v_exp_f32 v116, v116
    v_exp_f32 v117, v117
    v_exp_f32 v118, v118
    v_exp_f32 v119, v119
    v_exp_f32 v120, v120
    v_exp_f32 v121, v121
    v_exp_f32 v122, v122
    v_exp_f32 v123, v123
    s_add_u32 s96, s96, 0x10000
    s_add_u32 s97, s97, 0x10000
    v_pk_add_f32 v[110:111], v[110:111], 1.0 op_sel_hi:[1,0]
    v_pk_add_f32 v[112:113], v[112:113], 1.0 op_sel_hi:[1,0]
    v_pk_add_f32 v[114:115], v[114:115], 1.0 op_sel_hi:[1,0]
    v_pk_add_f32 v[116:117], v[116:117], 1.0 op_sel_hi:[1,0]
    v_pk_add_f32 v[118:119], v[118:119], 1.0 op_sel_hi:[1,0]
    v_pk_add_f32 v[120:121], v[120:121], 1.0 op_sel_hi:[1,0]
    v_pk_add_f32 v[122:123], v[122:123], 1.0 op_sel_hi:[1,0]
    v_rcp_f32 v110, v110
    v_rcp_f32 v111, v111
    v_rcp_f32 v112, v112
    v_rcp_f32 v113, v113
    v_rcp_f32 v114, v114
    v_rcp_f32 v115, v115
    v_rcp_f32 v116, v116
    v_rcp_f32 v117, v117
    v_rcp_f32 v118, v118
    v_rcp_f32 v119, v119
    v_rcp_f32 v120, v120
    v_rcp_f32 v121, v121
    v_rcp_f32 v122, v122
    v_rcp_f32 v123, v123
    v_pk_mul_f32 v[96:97], v[96:97], v[110:111]
    v_pk_mul_f32 v[98:99], v[98:99], v[112:113]
    v_pk_mul_f32 v[100:101], v[100:101], v[114:115]
    v_pk_mul_f32 v[102:103], v[102:103], v[116:117]
    v_pk_mul_f32 v[104:105], v[104:105], v[118:119]
    v_pk_mul_f32 v[106:107], v[106:107], v[120:121]
    v_pk_mul_f32 v[108:109], v[108:109], v[122:123]
    v_pk_mul_f32 v[52:53], v[96:97], v[32:33] op_sel_hi:[1,0]
    v_pk_fma_f32 v[52:53], v[98:99], v[34:35], v[52:53] op_sel_hi:[1,0,1]
    v_pk_fma_f32 v[52:53], v[100:101], v[36:37], v[52:53] op_sel_hi:[1,0,1]
    v_pk_fma_f32 v[52:53], v[102:103], v[38:39], v[52:53] op_sel_hi:[1,0,1]
    v_pk_fma_f32 v[52:53], v[104:105], v[40:41], v[52:53] op_sel_hi:[1,0,1]
    v_pk_fma_f32 v[52:53], v[106:107], v[42:43], v[52:53] op_sel_hi:[1,0,1]
    v_pk_fma_f32 v[52:53], v[108:109], v[44:45], v[52:53] op_sel_hi:[1,0,1]
    v_permlane32_swap_b32 v50, v51
    s_nop 0
    v_permlane32_swap_b32 v52, v53
    v_add_f32 v50, v50, v51
    v_add_f32 v52, v52, v53
    s_sub_u32 s98, s98, 1
    s_cmp_lg_u32 s98, 0
    v_permlane16_swap_b32 v50, v52
    v_add_f32 v50, v50, v52
    s_nop 1
    v_add_f32_dpp v50, v50, v50 row_ror:8 row_mask:0xf bank_mask:0xf
    s_nop 1
    v_add_f32_dpp v50, v50, v50 row_ror:4 row_mask:0xf bank_mask:0xf
    s_nop 1
    v_add_f32_dpp v50, v50, v50 row_ror:2 row_mask:0xf bank_mask:0xf
    s_nop 1
    v_add_f32_dpp v50, v50, v50 row_ror:1 row_mask:0xf bank_mask:0xf
    ds_write_b32 v242, v50
    v_add_u32 v242, 16, v242
    s_cbranch_scc1 L_tab
    s_waitcnt lgkmcnt(0)
    s_setpc_b64 s[100:101]
.p2alignl 12, 0xbf810000
L_tail:
    s_barrier
    global_load_dwordx4 v[184:187], v226, s[28:29] sc1
    global_load_dword v201, v200, s[26:27] sc1
    s_cmp_ge_u32 s32, 28
    s_cbranch_scc1 L_nowob
    s_add_u32 m0, s61, 0
    s_add_u32 s33, s51, 0
    buffer_load_dwordx4 v224, s[56:59], s33 offen nt lds
    s_add_u32 m0, s61, 1024
    s_add_u32 s33, s51, 7168
    buffer_load_dwordx4 v225, s[56:59], s33 offen nt lds
    s_add_u32 m0, s61, 2048
    s_add_u32 s33, s51, 14336
    buffer_load_dwordx4 v224, s[56:59], s33 offen nt lds
    s_add_u32 m0, s61, 3072
    s_add_u32 s33, s51, 21504
    buffer_load_dwordx4 v225, s[56:59], s33 offen nt lds
    s_add_u32 m0, s61, 4096
    s_add_u32 s33, s51, 28672
    buffer_load_dwordx4 v224, s[56:59], s33 offen nt lds
    s_add_u32 m0, s61, 5120
    s_add_u32 s33, s51, 35840
    buffer_load_dwordx4 v225, s[56:59], s33 offen nt lds
    s_add_u32 m0, s61, 6144
    s_add_u32 s33, s51, 43008
    buffer_load_dwordx4 v224, s[56:59], s33 offen nt lds
    s_add_u32 m0, s61, 7168
    s_add_u32 s33, s51, 50176
    buffer_load_dwordx4 v225, s[56:59], s33 offen nt lds
L_nowob:
    s_mov_b32 s35, 4294836224
    s_cmp_eq_u32 s62, 0
L_b3:
    s_barrier
    ds_read_b64 v[124:125], v238 offset:0
    ds_read_b64 v[126:127], v238 offset:2048
    ds_read_b64 v[128:129], v238 offset:4096
    ds_read_b64 v[130:131], v238 offset:6144
    s_waitcnt lgkmcnt(2)
    v_pk_add_f32 v[124:125], v[124:125], v[126:127]
    s_waitcnt lgkmcnt(1)
    v_pk_add_f32 v[124:125], v[124:125], v[128:129]
    s_waitcnt lgkmcnt(0)
    v_pk_add_f32 v[124:125], v[124:125], v[130:131]
    v_cvt_pk_bf16_f32 v124, v124, v125
    v_min_u32 v124, -2, v124
    s_cbranch_scc0 L_slowpub
    global_store_dword v230, v124, s[28:29]
L_pubd:
    s_cmp_ge_u32 s32, 28
    s_cbranch_scc1 L_hi
    s_waitcnt vmcnt(9)
    v_and_b32 v181, 4, v201
    v_cmp_ne_u32 s[6:7], 0, v181
    v_lshrrev_b32 v181, 20, v201
    v_add_u32 v181, -1, v181
    v_max3_u32 v181, v181, v184, v185
    v_max3_u32 v181, v181, v186, v187
    v_cmp_eq_u32_e64 vcc, -1, v181
    v_max3_f32 v182, v184, v185, v186
    v_max_f32 v182, v182, v187
    v_sub_f32 v184, v184, v182
    v_sub_f32 v185, v185, v182
    v_sub_f32 v186, v186, v182
    v_sub_f32 v187, v187, v182
    v_exp_f32 v184, v184
    v_exp_f32 v185, v185
    v_exp_f32 v186, v186
    v_exp_f32 v187, v187
    v_add_f32 v182, v184, v185
    v_add_f32 v183, v186, v187
    v_add_f32 v182, v182, v183
    v_rcp_f32 v182, v182
    s_nop 0
    v_mul_f32 v184, v184, v182
    v_mul_f32 v185, v185, v182
    v_mul_f32 v186, v186, v182
    v_mul_f32_e64 v187, v187, v182
    s_waitcnt vmcnt(5)
    global_load_dwordx4 v[156:159], v227, s[28:29] offset:0 sc1
    global_load_dwordx4 v[160:163], v227, s[28:29] offset:1024 sc1
    ds_read_b64_tr_b16 v[60:61], v241 offset:0
    ds_read_b64_tr_b16 v[62:63], v241 offset:512
    ds_read_b64_tr_b16 v[64:65], v93 offset:0
    ds_read_b64_tr_b16 v[66:67], v93 offset:512
    ds_read_b64_tr_b16 v[68:69], v94 offset:0
    ds_read_b64_tr_b16 v[70:71], v94 offset:512
    ds_read_b64_tr_b16 v[72:73], v95 offset:0
    ds_read_b64_tr_b16 v[74:75], v95 offset:512
    s_waitcnt vmcnt(3)
    ds_read_b64_tr_b16 v[76:77], v241 offset:4096
    ds_read_b64_tr_b16 v[78:79], v241 offset:4608
    ds_read_b64_tr_b16 v[80:81], v93 offset:4096
    ds_read_b64_tr_b16 v[82:83], v93 offset:4608
    ds_read_b64_tr_b16 v[84:85], v94 offset:4096
    ds_read_b64_tr_b16 v[86:87], v94 offset:4608
    ds_read_b64_tr_b16 v[88:89], v95 offset:4096
    ds_read_b64_tr_b16 v[90:91], v95 offset:4608
    s_cbranch_vccnz L_lretry
L_apoll0:
    s_bitcmp1_b32 s6, s60
    s_cselect_b32 s9, 8192, 0
    s_waitcnt vmcnt(0)
    v_max3_u32 v181, v156, v157, v158
    v_max3_u32 v181, v181, v159, v160
    v_max3_u32 v181, v181, v161, v162
    v_max_u32_e64 v181, v181, v163
    v_cmpx_eq_u32 vcc, -1, v181
    s_cbranch_execz L_adone
L_apoll:
    global_load_dwordx4 v[156:159], v227, s[28:29] offset:0 sc1
    global_load_dwordx4 v[160:163], v227, s[28:29] offset:1024 sc1
    s_add_u32 s35, s35, 1
    s_cselect_b32 s47, -1, -2
    s_waitcnt vmcnt(0)
    v_max3_u32 v181, v156, v157, v158
    v_max3_u32 v181, v181, v159, v160
    v_max3_u32 v181, v181, v161, v162
    v_max_u32 v181, v181, v163
    v_cmpx_lt_u32 vcc, s47, v181
    s_cbranch_execnz L_apoll
L_adone:
    s_mov_b64 exec, -1
    s_waitcnt lgkmcnt(6)
    s_mov_b32 s35, 4294836224
    v_mfma_f32_16x16x32_bf16 v[164:167], v[156:159], v[60:63], 0
    v_mfma_f32_16x16x32_bf16 v[164:167], v[160:163], v[76:79], v[164:167]
    v_add_u32 v229, s9, v229
    s_cmp_eq_u32 s45, 0
    v_mfma_f32_16x16x32_bf16 v[168:171], v[156:159], v[64:67], 0
    s_waitcnt lgkmcnt(4)
    s_nop 0
    v_mfma_f32_16x16x32_bf16 v[168:171], v[160:163], v[80:83], v[168:171]
    s_nop 1
    v_mfma_f32_16x16x32_bf16 v[172:175], v[156:159], v[68:71], 0
    s_waitcnt lgkmcnt(2)
    v_mul_f32 v196, v164, v184
    v_fmac_f32 v196, v165, v185
    v_mfma_f32_16x16x32_bf16 v[172:175], v[160:163], v[84:87], v[172:175]
    v_fmac_f32 v196, v166, v186
    v_fmac_f32 v196, v167, v187
    v_mfma_f32_16x16x32_bf16 v[176:179], v[156:159], v[72:75], 0
    s_waitcnt lgkmcnt(0)
    v_mul_f32 v197, v168, v184
    v_fmac_f32_e64 v197, v169, v185
    v_mfma_f32_16x16x32_bf16 v[176:179], v[160:163], v[88:91], v[176:179]
    v_fmac_f32 v197, v170, v186
    v_fmac_f32 v197, v171, v187
    ds_write2_b32 v228, v196, v197 offset0:0 offset1:16
    v_mul_f32 v198, v172, v184
    v_fmac_f32 v198, v173, v185
    v_fmac_f32 v198, v174, v186
    v_fmac_f32 v198, v175, v187
    s_nop 0
    v_mul_f32 v199, v176, v184
    v_fmac_f32 v199, v177, v185
    v_fmac_f32 v199, v178, v186
    v_fmac_f32_e64 v199, v179, v187
    ds_write2_b32 v228, v198, v199 offset0:32 offset1:48
    s_mov_b32 exec_hi, 0
    s_waitcnt lgkmcnt(0)
    s_barrier
    ds_read_b64 v[124:125], v239 offset:0
    ds_read_b64 v[126:127], v239 offset:1024
    ds_read_b64 v[128:129], v239 offset:2048
    ds_read_b64 v[130:131], v239 offset:3072
    s_waitcnt lgkmcnt(2)
    v_pk_add_f32 v[124:125], v[124:125], v[126:127]
    s_waitcnt lgkmcnt(1)
    v_pk_add_f32 v[124:125], v[124:125], v[128:129]
    s_waitcnt lgkmcnt(0)
    v_pk_add_f32 v[124:125], v[124:125], v[130:131]
    v_cvt_pk_bf16_f32 v124, v124, v125
    v_min_u32 v124, -2, v124
    s_cbranch_scc0 L_plain
    global_store_dword v229, v124, s[28:29] sc1
    s_endpgm
L_plain:
    global_store_dword v229, v124, s[28:29]
    s_endpgm
L_hi:
    s_sub_u32 s33, s32, 29
    s_cmp_le_u32 s33, 1
    s_cbranch_scc0 L_fin
    global_load_dwordx2 v[206:207], v244, s[4:5]
    s_mov_b64 s[56:57], s[28:29]
    s_mov_b32 s58, 864256
    s_mov_b32 s59, 0x20000
    s_mul_i32 s33, s30, 3072
    s_mov_b32 m0, s33
    s_add_u32 s33, s33, 851968
L_fl:
    s_waitcnt vmcnt(0)
    v_cmp_gt_u32 vcc, 0x100000, v201
    s_add_u32 s35, s35, 1
    s_cbranch_scc1 L_fld
    s_cbranch_vccz L_fld
    global_load_dword v201, v200, s[26:27] sc1
    s_branch L_fl
L_fld:
    v_readlane_b32 s34, v201, s31
    v_cndmask_b32 v206, 0, v206, s[42:43]
    v_cndmask_b32 v207, 0, v207, s[42:43]
    s_bitcmp1_b32 s34, 2
    s_cselect_b32 s34, 8192, 0
    v_lshlrev_b32 v204, 16, v206
    v_and_b32 v205, s38, v206
    v_lshlrev_b32 v206, 16, v207
    v_and_b32 v207, s38, v207
    v_add_u32 v233, s34, v233
    v_mov_b32 v180, 161024
    v_mov_b32 v198, 0x2edbe6ff
    s_mov_b32 s37, 905983488
    s_mov_b32 s44, 201264127
    v_cmp_lt_u32 s[14:15], 31, v0
    v_mov_b32 v202, 0x01000c0c
    v_mov_b32 v203, 0x03020c0c
    s_mov_b32 s35, 4294836224
    s_cmp_eq_u32 s32, 29
    s_cbranch_scc0 L_notd
    buffer_load_dwordx4 v3, s[56:59], s33 offen offset:0 sc1 lds
    buffer_load_dwordx4 v3, s[56:59], s33 offen offset:1024 sc1 lds
    buffer_load_dwordx4 v3, s[56:59], s33 offen offset:2048 sc1 lds
L_notd:
L_tpoll:
    global_load_dwordx4 v[156:159], v227, s[28:29] sc1
    s_add_u32 s35, s35, 1
    s_cselect_b32 s47, -1, -2
    s_waitcnt vmcnt(0)
    v_cmpx_lt_u32 vcc, s47, v156
    s_cbranch_execnz L_tpoll
    s_mov_b64 exec, -1
    s_mov_b32 s35, 4294836224
    s_waitcnt vmcnt(0)
    s_mov_b64 exec, s[42:43]
L_bpoll:
    global_load_dwordx4 v[140:143], v233, s[28:29] offset:0 sc1
    global_load_dwordx4 v[144:147], v233, s[28:29] offset:896 sc1
    global_load_dwordx4 v[148:151], v233, s[28:29] offset:1792 sc1
    global_load_dwordx4 v[152:155], v233, s[28:29] offset:2688 sc1
    s_add_u32 s35, s35, 1
    s_cselect_b32 s47, -1, -2
    s_mov_b64 exec, -1
    s_waitcnt vmcnt(3)
    v_mfma_f32_16x16x32_bf16 v[192:195], v[208:211], v[140:143], v[204:207]
    v_max3_u32 v181, v140, v141, v142
    v_max_u32 v181, v181, v143
    s_waitcnt vmcnt(2)
    v_mfma_f32_16x16x32_bf16 v[192:195], v[208:211], v[144:147], v[192:195]
    v_max3_u32 v181, v181, v144, v145
    v_max3_u32 v181, v181, v146, v147
    s_waitcnt vmcnt(1)
    v_mfma_f32_16x16x32_bf16 v[192:195], v[208:211], v[148:151], v[192:195]
    v_max3_u32 v181, v181, v148, v149
    v_max3_u32 v181, v181, v150, v151
    s_waitcnt vmcnt(0)
    v_mfma_f32_16x16x32_bf16 v[192:195], v[208:211], v[152:155], v[192:195]
    v_max3_u32 v181, v181, v152, v153
    v_max3_u32 v181, v181, v154, v155
    v_cmpx_lt_u32 vcc, s47, v181
    s_cbranch_execnz L_bpoll
    s_mov_b64 exec, -1
    s_cmp_eq_u32 s32, 29
    s_cbranch_scc0 L_w5
    s_nop 0
    v_pk_fma_f32 v[184:185], v[192:193], v[220:221], v[222:223] op_sel_hi:[1,0,0]
    v_pk_fma_f32 v[186:187], v[194:195], v[220:221], v[222:223] op_sel_hi:[1,0,0]
    v_pk_mul_f32 v[188:189], v[192:193], v[184:185]
    v_pk_fma_f32 v[188:189], v[194:195], v[186:187], v[188:189]
    v_add_f32_e64 v188, v188, v189
    v_cndmask_b32 v196, v192, v194, s[14:15]
    v_cndmask_b32 v197, v193, v195, s[14:15]
    v_add_f32_dpp v188, v188, v188 row_ror:8 row_mask:0xf bank_mask:0xf
    s_nop 1
    v_add_f32_dpp v188, v188, v188 row_ror:4 row_mask:0xf bank_mask:0xf
    s_nop 1
    v_add_f32_dpp v188, v188, v188 row_ror:2 row_mask:0xf bank_mask:0xf
    s_nop 1
    v_add_f32_dpp v188, v188, v188 row_ror:1 row_mask:0xf bank_mask:0xf
    s_nop 1
    v_add_f32_dpp v188, v188, v188 row_bcast:15 row_mask:0xa bank_mask:0xf
    s_mov_b64 exec, s[40:41]
    ds_write_b32 v234, v188
    s_mov_b64 exec, s[42:43]
    s_waitcnt lgkmcnt(0)
    s_barrier
    ds_read_b128 v[184:187], v180
    ds_read_b128 v[188:191], v180 offset:16
    s_waitcnt lgkmcnt(0)
    v_pk_add_f32 v[184:185], v[184:185], v[186:187]
    v_pk_add_f32 v[188:189], v[188:189], v[190:191]
    v_pk_add_f32 v[182:183], v[184:185], v[188:189]
    v_fma_f32 v183, -v182, v182, v183
    v_fma_f32 v183, |v183|, s36, v198
    v_rsq_f32 v184, v183
    v_pk_add_f32 v[192:193], v[196:197], v[182:183] op_sel_hi:[1,0] neg_lo:[0,1] neg_hi:[0,1]
    v_pk_mul_f32 v[192:193], v[192:193], v[184:185] op_sel_hi:[1,0]
    v_cvt_pk_bf16_f32 v194, v192, v193
    v_pk_sub_u16 v195, v194, s37
    v_pk_lshlrev_b16 v185, 2, v195 op_sel_hi:[0,1]
    v_and_b32 v184, 0xffff, v185
    v_lshrrev_b32_e64 v185, 16, v185
    ds_read_b32 v186, v184
    ds_read_b32 v187, v185
    v_cmp_gt_f32_e64 vcc, 0, v192
    v_cmp_gt_f32 s[6:7], 0, v193
    v_and_b32 v195, 0x7fff7fff, v195
    v_pk_sub_u16 v195, v195, s44 clamp
    v_cndmask_b32_e64 v188, v202, v203, vcc
    v_cndmask_b32 v189, v202, v203, s[6:7]
    v_cmp_ne_u32 vcc, 0, v195
    s_nop 1
    v_cndmask_b32 v190, 0, -1, vcc
    s_waitcnt lgkmcnt(0)
    v_max3_u32 v181, v186, v187, v190
    v_perm_b32 v186, v186, v186, v188
    v_perm_b32 v187, v187, v187, v189
    v_cmp_eq_u32 vcc, -1, v181
L_out:
    v_pk_add_f32 v[186:187], v[186:187], v[196:197]
    v_cvt_pk_bf16_f32 v186, v186, v187
    s_cbranch_vccnz L_miss
    global_store_dword v235, v186, s[24:25]
L_fin:
L_end:
    s_endpgm
L_lretry:
    global_load_dwordx4 v[184:187], v226, s[28:29] sc1
    global_load_dword v201, v200, s[26:27] sc1
    s_add_u32 s35, s35, 1
    s_waitcnt vmcnt(0)
    v_and_b32 v181, 4, v201
    v_cmp_ne_u32 s[6:7], 0, v181
    v_lshrrev_b32 v181, 20, v201
    v_add_u32 v181, -1, v181
    v_max3_u32 v181, v181, v184, v185
    v_max3_u32 v181, v181, v186, v187
    v_cmp_eq_u32 vcc, -1, v181
    v_max3_f32 v182, v184, v185, v186
    v_max_f32 v182, v182, v187
    v_sub_f32 v184, v184, v182
    v_sub_f32 v185, v185, v182
    v_sub_f32 v186, v186, v182
    v_sub_f32 v187, v187, v182
    v_exp_f32 v184, v184
    v_exp_f32 v185, v185
    v_exp_f32 v186, v186
    v_exp_f32 v187, v187
    v_add_f32 v182, v184, v185
    v_add_f32 v183, v186, v187
    v_add_f32 v182, v182, v183
    v_rcp_f32 v182, v182
    s_nop 0
    v_mul_f32 v184, v184, v182
    v_mul_f32 v185, v185, v182
    v_mul_f32 v186, v186, v182
    v_mul_f32 v187, v187, v182
    s_cbranch_scc1 L_lok
    s_cbranch_vccnz L_lretry
L_lok:
    s_mov_b32 s35, 4294836224
    s_branch L_apoll0
L_f1slow:
    v_mov_b32 v200, s63
    s_mov_b32 s35, 0
L_f1l:
    s_cmp_ge_u32 s46, 0x40000
    s_cbranch_scc1 L_f1d
    global_load_dword v201, v200, s[26:27] sc1
    s_add_u32 s35, s35, 1
    s_waitcnt vmcnt(0)
    v_readfirstlane_b32 s46, v201
    s_cmp_lt_u32 s35, 131072
    s_cbranch_scc1 L_f1l
L_f1d:
    s_cmp_eq_u32 s46, s47
    s_cbranch_scc1 L_same
    s_mov_b32 s41, s46
    s_add_u32 s46, s63, 32
    s_mov_b32 s47, 1
    s_atomic_add s47, s[26:27], s46 glc
    s_waitcnt lgkmcnt(0)
    s_mov_b32 s49, 1
    s_branch L_nopub
L_qretry:
    s_add_u32 s35, s35, 1
    s_cmp_ge_u32 s35, 131072
    s_cbranch_scc1 L_qdone
    s_bitcmp1_b32 s35, 0
    s_cbranch_scc1 L_qpoll
    v_mov_b32 v192, s63
    global_load_dword v193, v192, s[26:27] offset:32 sc1
    s_waitcnt vmcnt(0)
    v_readfirstlane_b32 s46, v193
    s_nop 0
    s_cmp_eq_u32 s46, 0
    s_cbranch_scc1 L_qpoll
L_glob:
    s_mov_b32 s49, 1
    v_mov_b32 v124, -1
    v_mov_b32 v125, -1
    v_mov_b32 v126, -1
    v_mov_b32 v127, -1
    s_lshl_b32 s33, s32, 10
    s_add_u32 s33, s33, s39
    s_add_u32 s33, s33, 1310720
    v_add_u32 v192, s33, v3
    v_add_u32 v193, 1048576, v231
    v_add_u32 v194, 1048576, v237
    v_add_u32 v180, 1048576, v180
    v_mov_b32 v195, s63
    global_store_dwordx4 v192, v[124:127], s[28:29] sc1
    s_bfe_u32 s33, s41, 0x10002
    s_lshl_b32 s33, s33, 13
    s_add_u32 s33, s33, s40
    v_add_u32 v192, s33, v3
    s_mov_b32 exec_hi, 0
    global_store_dwordx4 v192, v[124:127], s[28:29] sc1
    s_mov_b64 exec, 3
    global_store_dword v193, v124, s[28:29] sc1
    s_mov_b32 exec_lo, 0x00ff00ff
    s_mov_b32 exec_hi, 0x00ff00ff
    global_store_dwordx4 v194, v[212:215], s[28:29] offset:0 sc1
    global_store_dwordx4 v194, v[216:219], s[28:29] offset:64 sc1
    s_mov_b64 exec, -1
    s_add_u32 s46, s63, 64
    s_mov_b32 s47, 1
    s_mov_b32 s35, 0
    s_waitcnt vmcnt(0)
    s_atomic_add s47, s[26:27], s46
L_gl:
    global_load_dword v193, v195, s[26:27] offset:64 sc1
    s_add_u32 s35, s35, 1
    s_waitcnt vmcnt(0) lgkmcnt(0)
    v_readfirstlane_b32 s46, v193
    s_cmp_ge_u32 s35, 131072
    s_cselect_b32 s46, 32, s46
    s_cmp_lt_u32 s46, 32
    s_cbranch_scc1 L_gl
    global_load_dwordx4 v[124:127], v180, s[28:29] offset:0 sc1
    global_load_dwordx4 v[128:131], v180, s[28:29] offset:1024 sc1
    global_load_dwordx4 v[132:135], v180, s[28:29] offset:2048 sc1
    global_load_dwordx4 v[136:139], v180, s[28:29] offset:3072 sc1
    s_waitcnt vmcnt(0)
    s_branch L_qdone
L_qpoll:
    global_load_dwordx4 v[124:127], v180, s[28:29] offset:0 sc1
    global_load_dwordx4 v[128:131], v180, s[28:29] offset:1024 sc1
    global_load_dwordx4 v[132:135], v180, s[28:29] offset:2048 sc1
    global_load_dwordx4 v[136:139], v180, s[28:29] offset:3072 sc1
    s_branch L_qchk
L_slowlse:
    global_store_dword v231, v232, s[28:29] sc1
    s_branch L_lsed
L_slowpub:
    global_store_dword v230, v124, s[28:29] sc1
    s_branch L_pubd
L_w5:
    s_cmp_eq_u32 s30, 0
    s_cbranch_scc0 L_fin
    buffer_wbl2 sc1
    s_branch L_fin
L_miss:
    v_min_u32 v184, 12284, v184
    v_add_u32 v184, 851968, v184
    v_min_u32 v185, 12284, v185
    v_add_u32 v185, 851968, v185
    s_mov_b32 s35, 4294836224
L_ml:
    global_load_dword v186, v184, s[28:29] sc1
    global_load_dword v187, v185, s[28:29] sc1
    s_add_u32 s35, s35, 1
    s_waitcnt vmcnt(0)
    v_max_u32 v181, v186, v187
    v_cmp_eq_u32 vcc, -1, v181
    s_cbranch_scc1 L_mld
    s_cbranch_vccnz L_ml
L_mld:
    v_perm_b32 v186, v186, v186, v188
    v_perm_b32 v187, v187, v187, v189
    v_lshlrev_b32 v100, 16, v194
    v_and_b32 v101, s38, v194
    v_and_b32 v181, 0xffff, v195
    v_cmp_ne_u32 s[8:9], 0, v181
L_d0:
    s_nop 0
    s_cmp_eq_u64 s[8:9], 0
    s_cbranch_scc1 L_dd0
    s_ff1_i32_b64 s33, s[8:9]
    v_readlane_b32 s34, v100, s33
    s_mov_b64 exec, -1
    v_lshlrev_b32 v92, 1, v0
    v_mov_b32 v98, 0
    s_mov_b32 s33, 0
L_e0:
    global_load_ushort v93, v92, s[16:17]
    global_load_ushort v94, v92, s[18:19]
    global_load_ushort v95, v92, s[20:21]
    v_add_u32 v92, 128, v92
    s_waitcnt vmcnt(0)
    v_lshlrev_b32 v93, 16, v93
    v_lshlrev_b32 v94, 16, v94
    v_lshlrev_b32 v95, 16, v95
    v_fma_f32 v96, v93, s34, v94
    v_mul_f32 v97, v96, v96
    v_fma_f32 v97, v97, v46, v48
    v_mul_f32 v97, v97, v96
    v_exp_f32 v97, v97
    s_nop 0
    v_add_f32 v97, 1.0, v97
    v_rcp_f32 v97, v97
    s_nop 0
    v_mul_f32 v96, v96, v97
    v_fmac_f32 v98, v96, v95
    s_add_u32 s33, s33, 1
    s_cmp_lt_u32 s33, 28
    s_cbranch_scc1 L_e0
    v_add_f32_dpp v98, v98, v98 row_ror:8 row_mask:0xf bank_mask:0xf
    s_nop 1
    v_add_f32_dpp v98, v98, v98 row_ror:4 row_mask:0xf bank_mask:0xf
    s_nop 1
    v_add_f32_dpp v98, v98, v98 row_ror:2 row_mask:0xf bank_mask:0xf
    s_nop 1
    v_add_f32_dpp v98, v98, v98 row_ror:1 row_mask:0xf bank_mask:0xf
    v_mov_b32 v99, v98
    s_nop 1
    v_permlane32_swap_b32 v98, v99
    v_add_f32 v98, v98, v99
    v_mov_b32 v99, v98
    s_nop 1
    v_permlane16_swap_b32 v98, v99
    v_add_f32 v98, v98, v99
    v_add_f32 v98, v98, v236
    v_cvt_pk_bf16_f32 v98, v98, v98
    v_and_b32 v98, s38, v98
    s_mov_b64 exec, s[42:43]
    v_cmp_eq_u32 vcc, s34, v100
    s_nop 1
    v_cndmask_b32 v186, v186, v98, vcc
    s_andn2_b64 s[8:9], s[8:9], vcc
    s_branch L_d0
L_dd0:
    v_and_b32 v181, s38, v195
    v_cmp_ne_u32 s[8:9], 0, v181
L_d1:
    s_nop 0
    s_cmp_eq_u64 s[8:9], 0
    s_cbranch_scc1 L_dd1
    s_ff1_i32_b64 s33, s[8:9]
    v_readlane_b32 s34, v101, s33
    s_mov_b64 exec, -1
    v_lshlrev_b32 v92, 1, v0
    v_mov_b32 v98, 0
    s_mov_b32 s33, 0
L_e1:
    global_load_ushort v93, v92, s[16:17]
    global_load_ushort v94, v92, s[18:19]
    global_load_ushort v95, v92, s[20:21]
    v_add_u32 v92, 128, v92
    s_waitcnt vmcnt(0)
    v_lshlrev_b32 v93, 16, v93
    v_lshlrev_b32 v94, 16, v94
    v_lshlrev_b32 v95, 16, v95
    v_fma_f32 v96, v93, s34, v94
    v_mul_f32 v97, v96, v96
    v_fma_f32 v97, v97, v46, v48
    v_mul_f32 v97, v97, v96
    v_exp_f32 v97, v97
    s_nop 0
    v_add_f32 v97, 1.0, v97
    v_rcp_f32 v97, v97
    s_nop 0
    v_mul_f32 v96, v96, v97
    v_fmac_f32 v98, v96, v95
    s_add_u32 s33, s33, 1
    s_cmp_lt_u32 s33, 28
    s_cbranch_scc1 L_e1
    v_add_f32_dpp v98, v98, v98 row_ror:8 row_mask:0xf bank_mask:0xf
    s_nop 1
    v_add_f32_dpp v98, v98, v98 row_ror:4 row_mask:0xf bank_mask:0xf
    s_nop 1
    v_add_f32_dpp v98, v98, v98 row_ror:2 row_mask:0xf bank_mask:0xf
    s_nop 1
    v_add_f32_dpp v98, v98, v98 row_ror:1 row_mask:0xf bank_mask:0xf
    v_mov_b32 v99, v98
    s_nop 1
    v_permlane32_swap_b32 v98, v99
    v_add_f32 v98, v98, v99
    v_mov_b32 v99, v98
    s_nop 1
    v_permlane16_swap_b32 v98, v99
    v_add_f32 v98, v98, v99
    v_add_f32 v98, v98, v236
    v_cvt_pk_bf16_f32 v98, v98, v98
    v_and_b32 v98, s38, v98
    s_mov_b64 exec, s[42:43]
    v_cmp_eq_u32 vcc, s34, v101
    s_nop 1
    v_cndmask_b32 v187, v187, v98, vcc
    s_andn2_b64 s[8:9], s[8:9], vcc
    s_branch L_d1
L_dd1:
    s_mov_b64 vcc, 0
    s_branch L_out
.fill 1024, 4, 0xbf810000
.section .rodata,"a"
.p2align 6
.amdhsa_kernel sequential_preLN__sliding_block_cached__mixer_token_mlp__decode_kernel
  .amdhsa_next_free_vgpr 256
  .amdhsa_next_free_sgpr 102
  .amdhsa_accum_offset 256
  .amdhsa_group_segment_fixed_size 0
  .amdhsa_kernarg_size 104
  .amdhsa_user_sgpr_count 2
  .amdhsa_user_sgpr_kernarg_segment_ptr 1
  .amdhsa_system_sgpr_workgroup_id_x 1
  .amdhsa_float_denorm_mode_32 3
.end_amdhsa_kernel
```
